```python
import torch

def _softmax(x, axis=-1):
    return torch.softmax(x, dim=axis)
def _gelu(x):
    return torch.nn.functional.gelu(x, approximate="tanh")
def _silu(x):
    return torch.nn.functional.silu(x)
def _sigmoid(x):
    return torch.sigmoid(x)
def _layernorm(x, axis=-1, eps=1e-5):
    m = x.mean(dim=axis, keepdim=True)
    v = x.var(dim=axis, keepdim=True, unbiased=False)
    return (x - m) / torch.sqrt(v + eps)
def _scatter_add(tgt, idx, src, axis=0):
    return tgt.clone().index_add_(axis, idx, src)
def _segment_sum(src, seg, n):
    out = torch.zeros((n,) + src.shape[1:], dtype=src.dtype)
    return out.index_add_(0, seg, src)
def _pad(x, pw):
    flat = tuple(v for pair in reversed(pw) for v in pair)
    return torch.nn.functional.pad(x, flat)

kernel_name = 'gated_mix__gqa_block_cached__glu_gated_reglu__decode'

def setup_inputs():

    _w = (lambda a: (lambda t: t.to(torch.bfloat16) if t.is_floating_point() else t)(torch.as_tensor(a)))
    def _A_setup():
        B, Sq, D = 8, 1, 640
        Hq, Hkv, Sk, Dh = 32, 32, 4096, 128
        assert Hq % Hkv == 0, (Hq, Hkv)
        return {
            "x": _w((lambda *s: torch.randn(*s, dtype=torch.bfloat16) * 0.05)(B, Sq, D)),
            "k_cache": _w((lambda *s: torch.randn(*s, dtype=torch.bfloat16) * 3.2)(B, Hkv, Sk, Dh)),
            "v_cache": _w((lambda *s: torch.randn(*s, dtype=torch.bfloat16) * 0.05)(B, Hkv, Sk, Dh)),
            "wq": _w((lambda *s: torch.randn(*s, dtype=torch.bfloat16) * 3.2)(D, Hq * Dh) * (D ** -0.5)),
            "wo": _w((lambda *s: torch.randn(*s, dtype=torch.bfloat16) * 0.05)(Hq * Dh, D) * ((Hq * Dh) ** -0.5)),
        }
    _A_in = _A_setup()

    def _B_setup():
        B, S, D, F = 8, 1, 640, 1728
        return {
            "x": _w((lambda *s: torch.randn(*s, dtype=torch.bfloat16) * 0.05)(B, S, D)),
            "W_gate": _w((lambda *s: torch.randn(*s, dtype=torch.bfloat16) * 0.2)(D, F) * (2.0 / D) ** 0.5),
            "W_up": _w((lambda *s: torch.randn(*s, dtype=torch.bfloat16) * 0.2)(D, F) * (2.0 / D) ** 0.5),
            "W_down": _w((lambda *s: torch.randn(*s, dtype=torch.bfloat16) * 0.2)(F, D) * (1.0 / F) ** 0.5),
        }
    _B_in = _B_setup()

    return {
        "A_x": _A_in["x"],
        "A_k_cache": _A_in["k_cache"],
        "A_v_cache": _A_in["v_cache"],
        "A_wq": _A_in["wq"],
        "A_wo": _A_in["wo"],
        "B_x": _B_in["x"],
        "B_W_gate": _B_in["W_gate"],
        "B_W_up": _B_in["W_up"],
        "B_W_down": _B_in["W_down"],
        "gate_w": _w((lambda *s: torch.randn(*s, dtype=torch.bfloat16) * 0.05)(640) * 16.0),
    }

def reference(A_x, A_k_cache, A_v_cache, A_wq, A_wo, B_x, B_W_gate, B_W_up, B_W_down, gate_w):
    def _A_ref(x, k_cache, v_cache, wq, wo):
        B, Sq, D = x.shape
        Hq, Dh = 32, 128
        Hkv = k_cache.shape[1]
        rep = Hq // Hkv
        q = (lambda x, *d: x.permute(*d))((x @ wq).reshape(B, Sq, Hq, Dh), 0, 2, 1, 3)
        k = (lambda x, n, axis: torch.repeat_interleave(x, n, dim=axis))(k_cache, rep, axis=1)
        v = (lambda x, n, axis: torch.repeat_interleave(x, n, dim=axis))(v_cache, rep, axis=1)
        scores = torch.einsum("bhqd,bhkd->bhqk", q, k) * (Dh ** -0.5)
        p = _softmax(scores, axis=-1)
        o = torch.einsum("bhqk,bhkd->bhqd", p, v)
        return (lambda x, *d: x.permute(*d))(o, 0, 2, 1, 3).reshape(B, Sq, Hq * Dh) @ wo

    def _B_ref(x, W_gate, W_up, W_down):
        gate = torch.einsum("bsd,df->bsf", x, W_gate)
        up = torch.einsum("bsd,df->bsf", x, W_up)
        gate = gate * (lambda x, dt: x.to(dt))(gate > 0, gate.dtype)
        h = gate * up
        return torch.einsum("bsf,fd->bsd", h, W_down)

    x = A_x
    g = _sigmoid((x * gate_w).sum(-1, keepdims=True))
    a = _A_ref(x, A_k_cache, A_v_cache, A_wq, A_wo)
    b = _B_ref(x, B_W_gate, B_W_up, B_W_down)
    return g * a + (1 - g) * b
```

```asm
; @launch grid=(256,1,1) block=(512,1,1) lds=32896
.amdgcn_target "amdgcn-amd-amdhsa--gfx950"
.text
.globl gated_mix__gqa_block_cached__glu_gated_reglu__decode_kernel
.p2align 8
.type gated_mix__gqa_block_cached__glu_gated_reglu__decode_kernel,@function
gated_mix__gqa_block_cached__glu_gated_reglu__decode_kernel:
    s_cmp_ge_u32 s2, 256
    s_cbranch_scc1 L_end
    s_getpc_b64 s[66:67]
L_pc0:
    s_load_dwordx16 s[4:19], s[0:1], 0
    s_load_dwordx8 s[20:27], s[0:1], 64
    s_load_dwordx2 s[28:29], s[0:1], 96
    v_lshrrev_b32 v1, 6, v0
    v_and_b32 v0, 63, v0
    v_readfirstlane_b32 s32, v1
    s_lshr_b32 s30, s2, 5
    s_and_b32 s31, s2, 31
    s_lshl_b32 s2, s30, 5
    s_or_b32 s2, s2, s31
    v_and_b32 v1, 15, v0
    v_lshrrev_b32 v2, 4, v0
    s_cmp_ge_u32 s32, 4
    s_cbranch_scc1 L_helper
    s_setprio 2
    v_lshlrev_b32 v3, 4, v0
    s_lshl_b32 s33, s2, 20
    s_lshl_b32 s44, s32, 12
    s_xor_b32 s46, s32, 0
    s_lshl_b32 s46, s46, 12
    v_add_u32 v224, s46, v3
    s_xor_b32 s46, s32, 1
    s_lshl_b32 s46, s46, 12
    v_add_u32 v225, s46, v3
    s_xor_b32 s46, s32, 2
    s_lshl_b32 s46, s46, 12
    v_add_u32 v226, s46, v3
    s_xor_b32 s46, s32, 3
    s_lshl_b32 s46, s46, 12
    v_add_u32 v227, s46, v3
    s_mov_b32 s44, 0
    s_mov_b32 s45, s44
    s_waitcnt lgkmcnt(0)
    s_add_u32 s36, s6, s33
    s_addc_u32 s37, s7, 0
    s_mov_b32 s38, 0x100000
    s_mov_b32 s39, 0x20000
    s_add_u32 s40, s8, s33
    s_addc_u32 s41, s9, 0
    s_mov_b32 s42, 0x100000
    s_mov_b32 s43, 0x20000
    buffer_load_dwordx4 v[64:67], v224, s[36:39], s44 offen offset:0 nt
    buffer_load_dwordx4 v[68:71], v224, s[36:39], s44 offen offset:1024 nt
    buffer_load_dwordx4 v[72:75], v224, s[36:39], s44 offen offset:2048 nt
    buffer_load_dwordx4 v[76:79], v224, s[36:39], s44 offen offset:3072 nt
    s_add_u32 s44, s44, 16384
    s_branch L_stream
L_helper:
    s_setprio 3
    v_and_b32 v5, 1, v1
    v_mov_b32 v7, 0xffff
    v_cmp_eq_u32 vcc, 1, v5
    v_mov_b32 v5, 0xffff0000
    s_nop 0
    v_cndmask_b32 v5, v7, v5, vcc
    v_lshrrev_b32 v7, 1, v1
    v_cmp_eq_u32 vcc, 0, v7
    s_nop 1
    v_cndmask_b32 v36, 0, v5, vcc
    v_cmp_eq_u32 vcc, 1, v7
    s_nop 1
    v_cndmask_b32 v37, 0, v5, vcc
    v_cmp_eq_u32 vcc, 2, v7
    s_nop 1
    v_cndmask_b32 v38, 0, v5, vcc
    v_cmp_eq_u32 vcc, 3, v7
    s_nop 1
    v_cndmask_b32 v39, 0, v5, vcc
    v_and_b32 v5, 1, v1
    v_cmp_eq_u32 vcc, 1, v5
    v_mov_b32 v5, 0x0c0c0100
    v_mov_b32 v7, 0x01000c0c
    v_cndmask_b32 v76, v5, v7, vcc
    v_mov_b32 v5, 0x0c0c0302
    v_mov_b32 v7, 0x03020c0c
    v_cndmask_b32 v77, v5, v7, vcc
    v_lshrrev_b32 v5, 1, v1
    v_mov_b32 v7, 0x0c0c0c0c
    v_cmp_eq_u32 vcc, 0, v5
    s_nop 1
    v_cndmask_b32 v28, v7, v76, vcc
    v_cndmask_b32 v32, v7, v77, vcc
    v_cmp_eq_u32 vcc, 1, v5
    s_nop 1
    v_cndmask_b32 v29, v7, v76, vcc
    v_cndmask_b32 v33, v7, v77, vcc
    v_cmp_eq_u32 vcc, 2, v5
    s_nop 1
    v_cndmask_b32 v30, v7, v76, vcc
    v_cndmask_b32 v34, v7, v77, vcc
    v_cmp_eq_u32 vcc, 3, v5
    s_nop 1
    v_cndmask_b32 v31, v7, v76, vcc
    v_cndmask_b32 v35, v7, v77, vcc
    v_mov_b32 v5, 0
    v_mov_b32 v7, 22592
    s_cmp_eq_u32 s32, 4
    s_cbranch_scc0 L_nocnt
    s_mov_b64 exec, 1
    ds_write_b32 v7, v5
    ds_write_b32 v7, v5 offset:4
    v_mov_b32 v5, 3137
    ds_write_b32 v7, v5 offset:8
    v_mov_b32 v5, 0
    ds_write_b32 v7, v5 offset:16
    v_mov_b32 v5, -1
    ds_write_b32 v7, v5 offset:12
    s_mov_b64 exec, -1
L_nocnt:
    s_sub_u32 s33, s32, 4
    s_mul_i32 s52, s30, 1280
    s_mul_i32 s53, s33, 320
    v_mul_u32_u24 v3, 80, v2
    v_add_u32 v3, s53, v3
    v_lshlrev_b32 v6, 5, v0
    s_mul_i32 s53, s33, 1310720
    v_mul_u32_u24 v4, 40, v2
    v_lshlrev_b32 v4, 13, v4
    v_lshl_or_b32 v4, v1, 4, v4
    v_add_u32 v4, s53, v4
    s_lshl_b32 s54, s31, 8
    s_waitcnt lgkmcnt(0)
    s_add_u32 s36, s4, s52
    s_addc_u32 s37, s5, 0
    s_mov_b32 s38, 1280
    s_mov_b32 s39, 0x20000
    s_add_u32 s40, s10, s54
    s_addc_u32 s41, s11, 0
    s_sub_u32 s42, 5242880, s54
    s_mov_b32 s43, 0x20000
    s_mov_b32 s48, s22
    s_mov_b32 s49, s23
    s_mov_b32 s50, 1280
    s_mov_b32 s51, 0x20000
    s_cmp_ge_u32 s30, 5
    s_cselect_b32 s56, 5, 0
    s_sub_u32 s56, s30, s56
    s_lshl_b32 s57, s56, 4
    buffer_load_dwordx4 v[8:11], v3, s[36:39], s57 offen
    s_add_u32 s57, s57, 16
    s_cmp_eq_u32 s57, 80
    s_cselect_b32 s57, 0, s57
    buffer_load_dwordx4 v[12:15], v3, s[36:39], s57 offen
    s_add_u32 s57, s57, 16
    s_cmp_eq_u32 s57, 80
    s_cselect_b32 s57, 0, s57
    buffer_load_dwordx4 v[16:19], v3, s[36:39], s57 offen
    s_add_u32 s57, s57, 16
    s_cmp_eq_u32 s57, 80
    s_cselect_b32 s57, 0, s57
    buffer_load_dwordx4 v[20:23], v3, s[36:39], s57 offen
    s_add_u32 s57, s57, 16
    s_cmp_eq_u32 s57, 80
    s_cselect_b32 s57, 0, s57
    buffer_load_dwordx4 v[24:27], v3, s[36:39], s57 offen
    s_lshl_b32 s55, s56, 16
    buffer_load_dwordx4 v[80:83], v4, s[40:43], s55 offen
    s_add_u32 s55, s55, 8192
    buffer_load_dwordx4 v[84:87], v4, s[40:43], s55 offen
    s_add_u32 s55, s55, 8192
    buffer_load_dwordx4 v[88:91], v4, s[40:43], s55 offen
    s_add_u32 s55, s55, 8192
    buffer_load_dwordx4 v[92:95], v4, s[40:43], s55 offen
    s_add_u32 s55, s55, 8192
    buffer_load_dwordx4 v[96:99], v4, s[40:43], s55 offen
    s_add_u32 s55, s55, 8192
    buffer_load_dwordx4 v[100:103], v4, s[40:43], s55 offen
    s_add_u32 s55, s55, 8192
    buffer_load_dwordx4 v[104:107], v4, s[40:43], s55 offen
    s_add_u32 s55, s55, 8192
    buffer_load_dwordx4 v[108:111], v4, s[40:43], s55 offen
    s_add_u32 s55, s55, 8192
    s_cmp_eq_u32 s55, 327680
    s_cselect_b32 s55, 0, s55
    buffer_load_dwordx4 v[112:115], v4, s[40:43], s55 offen
    s_add_u32 s55, s55, 8192
    buffer_load_dwordx4 v[116:119], v4, s[40:43], s55 offen
    s_add_u32 s55, s55, 8192
    s_waitcnt vmcnt(10)
    v_perm_b32 v40, v8, v8, v28
    v_perm_b32 v41, v8, v8, v29
    v_perm_b32 v42, v8, v8, v30
    v_perm_b32 v43, v8, v8, v31
    buffer_load_dwordx4 v[120:123], v4, s[40:43], s55 offen
    s_add_u32 s55, s55, 8192
    v_perm_b32 v44, v8, v8, v32
    v_perm_b32 v45, v8, v8, v33
    v_perm_b32 v46, v8, v8, v34
    v_perm_b32 v47, v8, v8, v35
    s_waitcnt vmcnt(10)
    v_mfma_f32_16x16x32_bf16 v[48:51], v[80:83], v[40:43], 0
    buffer_load_dwordx4 v[124:127], v4, s[40:43], s55 offen
    s_add_u32 s55, s55, 8192
    v_perm_b32 v40, v9, v9, v28
    v_perm_b32 v41, v9, v9, v29
    v_perm_b32 v42, v9, v9, v30
    v_perm_b32 v43, v9, v9, v31
    s_waitcnt vmcnt(10)
    v_mfma_f32_16x16x32_bf16 v[48:51], v[84:87], v[44:47], v[48:51]
    buffer_load_dwordx4 v[128:131], v4, s[40:43], s55 offen
    s_add_u32 s55, s55, 8192
    v_perm_b32 v44, v9, v9, v32
    v_perm_b32 v45, v9, v9, v33
    v_perm_b32 v46, v9, v9, v34
    v_perm_b32 v47, v9, v9, v35
    s_waitcnt vmcnt(10)
    v_mfma_f32_16x16x32_bf16 v[48:51], v[88:91], v[40:43], v[48:51]
    buffer_load_dwordx4 v[132:135], v4, s[40:43], s55 offen
    s_add_u32 s55, s55, 8192
    v_perm_b32 v40, v10, v10, v28
    v_perm_b32 v41, v10, v10, v29
    v_perm_b32 v42, v10, v10, v30
    v_perm_b32 v43, v10, v10, v31
    s_waitcnt vmcnt(10)
    v_mfma_f32_16x16x32_bf16 v[48:51], v[92:95], v[44:47], v[48:51]
    buffer_load_dwordx4 v[136:139], v4, s[40:43], s55 offen
    s_add_u32 s55, s55, 8192
    v_perm_b32 v44, v10, v10, v32
    v_perm_b32 v45, v10, v10, v33
    v_perm_b32 v46, v10, v10, v34
    v_perm_b32 v47, v10, v10, v35
    s_waitcnt vmcnt(10)
    v_mfma_f32_16x16x32_bf16 v[48:51], v[96:99], v[40:43], v[48:51]
    buffer_load_dwordx4 v[140:143], v4, s[40:43], s55 offen
    s_add_u32 s55, s55, 8192
    s_cmp_eq_u32 s55, 327680
    s_cselect_b32 s55, 0, s55
    v_perm_b32 v40, v11, v11, v28
    v_perm_b32 v41, v11, v11, v29
    v_perm_b32 v42, v11, v11, v30
    v_perm_b32 v43, v11, v11, v31
    s_waitcnt vmcnt(10)
    v_mfma_f32_16x16x32_bf16 v[48:51], v[100:103], v[44:47], v[48:51]
    buffer_load_dwordx4 v[144:147], v4, s[40:43], s55 offen
    s_add_u32 s55, s55, 8192
    v_perm_b32 v44, v11, v11, v32
    v_perm_b32 v45, v11, v11, v33
    v_perm_b32 v46, v11, v11, v34
    v_perm_b32 v47, v11, v11, v35
    s_waitcnt vmcnt(10)
    v_mfma_f32_16x16x32_bf16 v[48:51], v[104:107], v[40:43], v[48:51]
    buffer_load_dwordx4 v[148:151], v4, s[40:43], s55 offen
    s_add_u32 s55, s55, 8192
    v_perm_b32 v40, v12, v12, v28
    v_perm_b32 v41, v12, v12, v29
    v_perm_b32 v42, v12, v12, v30
    v_perm_b32 v43, v12, v12, v31
    s_waitcnt vmcnt(10)
    v_mfma_f32_16x16x32_bf16 v[48:51], v[108:111], v[44:47], v[48:51]
    buffer_load_dwordx4 v[152:155], v4, s[40:43], s55 offen
    s_add_u32 s55, s55, 8192
    v_perm_b32 v44, v12, v12, v32
    v_perm_b32 v45, v12, v12, v33
    v_perm_b32 v46, v12, v12, v34
    v_perm_b32 v47, v12, v12, v35
    s_waitcnt vmcnt(10)
    v_mfma_f32_16x16x32_bf16 v[48:51], v[112:115], v[40:43], v[48:51]
    buffer_load_dwordx4 v[156:159], v4, s[40:43], s55 offen
    s_add_u32 s55, s55, 8192
    v_perm_b32 v40, v13, v13, v28
    v_perm_b32 v41, v13, v13, v29
    v_perm_b32 v42, v13, v13, v30
    v_perm_b32 v43, v13, v13, v31
    s_waitcnt vmcnt(10)
    v_mfma_f32_16x16x32_bf16 v[48:51], v[116:119], v[44:47], v[48:51]
    buffer_load_dwordx4 v[160:163], v4, s[40:43], s55 offen
    s_add_u32 s55, s55, 8192
    v_perm_b32 v44, v13, v13, v32
    v_perm_b32 v45, v13, v13, v33
    v_perm_b32 v46, v13, v13, v34
    v_perm_b32 v47, v13, v13, v35
    s_waitcnt vmcnt(10)
    v_mfma_f32_16x16x32_bf16 v[48:51], v[120:123], v[40:43], v[48:51]
    buffer_load_dwordx4 v[164:167], v4, s[40:43], s55 offen
    s_add_u32 s55, s55, 8192
    v_perm_b32 v40, v14, v14, v28
    v_perm_b32 v41, v14, v14, v29
    v_perm_b32 v42, v14, v14, v30
    v_perm_b32 v43, v14, v14, v31
    s_waitcnt vmcnt(10)
    v_mfma_f32_16x16x32_bf16 v[48:51], v[124:127], v[44:47], v[48:51]
    buffer_load_dwordx4 v[168:171], v4, s[40:43], s55 offen
    s_add_u32 s55, s55, 8192
    v_perm_b32 v44, v14, v14, v32
    v_perm_b32 v45, v14, v14, v33
    v_perm_b32 v46, v14, v14, v34
    v_perm_b32 v47, v14, v14, v35
    s_waitcnt vmcnt(10)
    v_mfma_f32_16x16x32_bf16 v[48:51], v[128:131], v[40:43], v[48:51]
    buffer_load_dwordx4 v[172:175], v4, s[40:43], s55 offen
    s_add_u32 s55, s55, 8192
    s_cmp_eq_u32 s55, 327680
    s_cselect_b32 s55, 0, s55
    v_perm_b32 v40, v15, v15, v28
    v_perm_b32 v41, v15, v15, v29
    v_perm_b32 v42, v15, v15, v30
    v_perm_b32 v43, v15, v15, v31
    s_waitcnt vmcnt(10)
    v_mfma_f32_16x16x32_bf16 v[48:51], v[132:135], v[44:47], v[48:51]
    buffer_load_dwordx4 v[176:179], v4, s[40:43], s55 offen
    s_add_u32 s55, s55, 8192
    v_perm_b32 v44, v15, v15, v32
    v_perm_b32 v45, v15, v15, v33
    v_perm_b32 v46, v15, v15, v34
    v_perm_b32 v47, v15, v15, v35
    s_waitcnt vmcnt(10)
    v_mfma_f32_16x16x32_bf16 v[48:51], v[136:139], v[40:43], v[48:51]
    buffer_load_dwordx4 v[180:183], v4, s[40:43], s55 offen
    s_add_u32 s55, s55, 8192
    v_perm_b32 v40, v16, v16, v28
    v_perm_b32 v41, v16, v16, v29
    v_perm_b32 v42, v16, v16, v30
    v_perm_b32 v43, v16, v16, v31
    s_waitcnt vmcnt(10)
    v_mfma_f32_16x16x32_bf16 v[48:51], v[140:143], v[44:47], v[48:51]
    buffer_load_dwordx4 v[184:187], v4, s[40:43], s55 offen
    s_add_u32 s55, s55, 8192
    v_perm_b32 v44, v16, v16, v32
    v_perm_b32 v45, v16, v16, v33
    v_perm_b32 v46, v16, v16, v34
    v_perm_b32 v47, v16, v16, v35
    s_waitcnt vmcnt(10)
    v_mfma_f32_16x16x32_bf16 v[48:51], v[144:147], v[40:43], v[48:51]
    buffer_load_dwordx4 v[188:191], v4, s[40:43], s55 offen
    s_add_u32 s55, s55, 8192
    v_perm_b32 v40, v17, v17, v28
    v_perm_b32 v41, v17, v17, v29
    v_perm_b32 v42, v17, v17, v30
    v_perm_b32 v43, v17, v17, v31
    s_waitcnt vmcnt(10)
    v_mfma_f32_16x16x32_bf16 v[48:51], v[148:151], v[44:47], v[48:51]
    buffer_load_dwordx4 v[192:195], v4, s[40:43], s55 offen
    s_add_u32 s55, s55, 8192
    v_perm_b32 v44, v17, v17, v32
    v_perm_b32 v45, v17, v17, v33
    v_perm_b32 v46, v17, v17, v34
    v_perm_b32 v47, v17, v17, v35
    s_waitcnt vmcnt(10)
    v_mfma_f32_16x16x32_bf16 v[48:51], v[152:155], v[40:43], v[48:51]
    buffer_load_dwordx4 v[196:199], v4, s[40:43], s55 offen
    s_add_u32 s55, s55, 8192
    v_perm_b32 v40, v18, v18, v28
    v_perm_b32 v41, v18, v18, v29
    v_perm_b32 v42, v18, v18, v30
    v_perm_b32 v43, v18, v18, v31
    s_waitcnt vmcnt(10)
    v_mfma_f32_16x16x32_bf16 v[48:51], v[156:159], v[44:47], v[48:51]
    buffer_load_dwordx4 v[200:203], v4, s[40:43], s55 offen
    s_add_u32 s55, s55, 8192
    v_perm_b32 v44, v18, v18, v32
    v_perm_b32 v45, v18, v18, v33
    v_perm_b32 v46, v18, v18, v34
    v_perm_b32 v47, v18, v18, v35
    s_waitcnt vmcnt(10)
    v_mfma_f32_16x16x32_bf16 v[48:51], v[160:163], v[40:43], v[48:51]
    buffer_load_dwordx4 v[204:207], v4, s[40:43], s55 offen
    s_add_u32 s55, s55, 8192
    s_cmp_eq_u32 s55, 327680
    s_cselect_b32 s55, 0, s55
    v_perm_b32 v40, v19, v19, v28
    v_perm_b32 v41, v19, v19, v29
    v_perm_b32 v42, v19, v19, v30
    v_perm_b32 v43, v19, v19, v31
    s_waitcnt vmcnt(10)
    v_mfma_f32_16x16x32_bf16 v[48:51], v[164:167], v[44:47], v[48:51]
    buffer_load_dwordx4 v[208:211], v4, s[40:43], s55 offen
    s_add_u32 s55, s55, 8192
    v_perm_b32 v44, v19, v19, v32
    v_perm_b32 v45, v19, v19, v33
    v_perm_b32 v46, v19, v19, v34
    v_perm_b32 v47, v19, v19, v35
    s_waitcnt vmcnt(10)
    v_mfma_f32_16x16x32_bf16 v[48:51], v[168:171], v[40:43], v[48:51]
    buffer_load_dwordx4 v[212:215], v4, s[40:43], s55 offen
    s_add_u32 s55, s55, 8192
    v_perm_b32 v40, v20, v20, v28
    v_perm_b32 v41, v20, v20, v29
    v_perm_b32 v42, v20, v20, v30
    v_perm_b32 v43, v20, v20, v31
    s_waitcnt vmcnt(10)
    v_mfma_f32_16x16x32_bf16 v[48:51], v[172:175], v[44:47], v[48:51]
    buffer_load_dwordx4 v[216:219], v4, s[40:43], s55 offen
    s_add_u32 s55, s55, 8192
    v_perm_b32 v44, v20, v20, v32
    v_perm_b32 v45, v20, v20, v33
    v_perm_b32 v46, v20, v20, v34
    v_perm_b32 v47, v20, v20, v35
    s_waitcnt vmcnt(10)
    v_mfma_f32_16x16x32_bf16 v[48:51], v[176:179], v[40:43], v[48:51]
    buffer_load_dwordx4 v[220:223], v4, s[40:43], s55 offen
    s_add_u32 s55, s55, 8192
    v_perm_b32 v40, v21, v21, v28
    v_perm_b32 v41, v21, v21, v29
    v_perm_b32 v42, v21, v21, v30
    v_perm_b32 v43, v21, v21, v31
    s_waitcnt vmcnt(10)
    v_mfma_f32_16x16x32_bf16 v[48:51], v[180:183], v[44:47], v[48:51]
    buffer_load_dwordx4 v[224:227], v4, s[40:43], s55 offen
    s_add_u32 s55, s55, 8192
    v_perm_b32 v44, v21, v21, v32
    v_perm_b32 v45, v21, v21, v33
    v_perm_b32 v46, v21, v21, v34
    v_perm_b32 v47, v21, v21, v35
    s_waitcnt vmcnt(10)
    v_mfma_f32_16x16x32_bf16 v[48:51], v[184:187], v[40:43], v[48:51]
    buffer_load_dwordx4 v[228:231], v4, s[40:43], s55 offen
    s_add_u32 s55, s55, 8192
    v_perm_b32 v40, v22, v22, v28
    v_perm_b32 v41, v22, v22, v29
    v_perm_b32 v42, v22, v22, v30
    v_perm_b32 v43, v22, v22, v31
    s_waitcnt vmcnt(10)
    v_mfma_f32_16x16x32_bf16 v[48:51], v[188:191], v[44:47], v[48:51]
    buffer_load_dwordx4 v[232:235], v4, s[40:43], s55 offen
    s_add_u32 s55, s55, 8192
    v_perm_b32 v44, v22, v22, v32
    v_perm_b32 v45, v22, v22, v33
    v_perm_b32 v46, v22, v22, v34
    v_perm_b32 v47, v22, v22, v35
    s_waitcnt vmcnt(10)
    v_mfma_f32_16x16x32_bf16 v[48:51], v[192:195], v[40:43], v[48:51]
    buffer_load_dwordx4 v[236:239], v4, s[40:43], s55 offen
    s_barrier
    v_perm_b32 v40, v23, v23, v28
    v_perm_b32 v41, v23, v23, v29
    v_perm_b32 v42, v23, v23, v30
    v_perm_b32 v43, v23, v23, v31
    s_waitcnt vmcnt(10)
    v_mfma_f32_16x16x32_bf16 v[48:51], v[196:199], v[44:47], v[48:51]
    v_perm_b32 v44, v23, v23, v32
    v_perm_b32 v45, v23, v23, v33
    v_perm_b32 v46, v23, v23, v34
    v_perm_b32 v47, v23, v23, v35
    s_waitcnt vmcnt(9)
    v_mfma_f32_16x16x32_bf16 v[48:51], v[200:203], v[40:43], v[48:51]
    v_perm_b32 v40, v24, v24, v28
    v_perm_b32 v41, v24, v24, v29
    v_perm_b32 v42, v24, v24, v30
    v_perm_b32 v43, v24, v24, v31
    s_waitcnt vmcnt(8)
    v_mfma_f32_16x16x32_bf16 v[48:51], v[204:207], v[44:47], v[48:51]
    v_perm_b32 v44, v24, v24, v32
    v_perm_b32 v45, v24, v24, v33
    v_perm_b32 v46, v24, v24, v34
    v_perm_b32 v47, v24, v24, v35
    s_waitcnt vmcnt(7)
    v_mfma_f32_16x16x32_bf16 v[48:51], v[208:211], v[40:43], v[48:51]
    v_perm_b32 v40, v25, v25, v28
    v_perm_b32 v41, v25, v25, v29
    v_perm_b32 v42, v25, v25, v30
    v_perm_b32 v43, v25, v25, v31
    s_waitcnt vmcnt(6)
    v_mfma_f32_16x16x32_bf16 v[48:51], v[212:215], v[44:47], v[48:51]
    v_perm_b32 v44, v25, v25, v32
    v_perm_b32 v45, v25, v25, v33
    v_perm_b32 v46, v25, v25, v34
    v_perm_b32 v47, v25, v25, v35
    s_waitcnt vmcnt(5)
    v_mfma_f32_16x16x32_bf16 v[48:51], v[216:219], v[40:43], v[48:51]
    v_perm_b32 v40, v26, v26, v28
    v_perm_b32 v41, v26, v26, v29
    v_perm_b32 v42, v26, v26, v30
    v_perm_b32 v43, v26, v26, v31
    s_waitcnt vmcnt(4)
    v_mfma_f32_16x16x32_bf16 v[48:51], v[220:223], v[44:47], v[48:51]
    v_perm_b32 v44, v26, v26, v32
    v_perm_b32 v45, v26, v26, v33
    v_perm_b32 v46, v26, v26, v34
    v_perm_b32 v47, v26, v26, v35
    s_waitcnt vmcnt(3)
    v_mfma_f32_16x16x32_bf16 v[48:51], v[224:227], v[40:43], v[48:51]
    v_perm_b32 v40, v27, v27, v28
    v_perm_b32 v41, v27, v27, v29
    v_perm_b32 v42, v27, v27, v30
    v_perm_b32 v43, v27, v27, v31
    s_waitcnt vmcnt(2)
    v_mfma_f32_16x16x32_bf16 v[48:51], v[228:231], v[44:47], v[48:51]
    v_perm_b32 v44, v27, v27, v32
    v_perm_b32 v45, v27, v27, v33
    v_perm_b32 v46, v27, v27, v34
    v_perm_b32 v47, v27, v27, v35
    s_waitcnt vmcnt(1)
    v_mfma_f32_16x16x32_bf16 v[48:51], v[232:235], v[40:43], v[48:51]
    s_nop 1
    s_waitcnt vmcnt(0)
    v_mfma_f32_16x16x32_bf16 v[48:51], v[236:239], v[44:47], v[48:51]
    v_lshlrev_b32 v5, 7, v2
    v_lshl_or_b32 v5, v1, 2, v5
    s_lshl_b32 s55, s33, 9
    v_add_u32 v5, s55, v5
    s_nop 7
    s_mov_b32 exec_lo, 0x00ff00ff
    s_mov_b32 exec_hi, 0x00ff00ff
    ds_write_b32 v5, v48 offset:16384
    ds_write_b32 v5, v49 offset:16416
    ds_write_b32 v5, v50 offset:16448
    ds_write_b32 v5, v51 offset:16480
    s_mov_b64 exec, -1
    s_waitcnt lgkmcnt(0)
    s_barrier
    s_setprio 0
    s_cmp_eq_u32 s33, 1
    s_cbranch_scc0 L_noclear
    s_mul_i32 s53, s30, 81920
    s_add_u32 s44, s28, s53
    s_addc_u32 s45, s29, 0
    s_mov_b32 s46, 81920
    s_mov_b32 s47, 0x20000
    s_mul_i32 s53, s31, 2560
    v_lshlrev_b32 v6, 4, v0
    v_mov_b32 v240, 0x7fa5c3e1
    v_mov_b32 v241, 0x7fa5c3e1
    v_mov_b32 v242, 0x7fa5c3e1
    v_mov_b32 v243, 0x7fa5c3e1
    buffer_store_dwordx4 v[240:243], v6, s[44:47], s53 offen sc1
    buffer_store_dwordx4 v[240:243], v6, s[44:47], s53 offen offset:1024 sc1
    s_mov_b32 exec_hi, 0
    buffer_store_dwordx4 v[240:243], v6, s[44:47], s53 offen offset:2048 sc1
    s_mov_b64 exec, -1
    s_waitcnt vmcnt(0)
L_noclear:
    v_lshlrev_b32 v6, 5, v0
    buffer_load_dwordx4 v[68:71], v6, s[36:39], 0 offen
    buffer_load_dwordx4 v[72:75], v6, s[36:39], 0 offen offset:16
    buffer_load_dwordx4 v[240:243], v6, s[48:51], 0 offen
    buffer_load_dwordx4 v[244:247], v6, s[48:51], 0 offen offset:16
    s_waitcnt vmcnt(0)
    v_dot2_f32_bf16 v6, v68, v240, 0
    v_dot2_f32_bf16 v6, v69, v241, v6
    v_dot2_f32_bf16 v6, v70, v242, v6
    v_dot2_f32_bf16 v6, v71, v243, v6
    v_dot2_f32_bf16 v6, v72, v244, v6
    v_dot2_f32_bf16 v6, v73, v245, v6
    v_dot2_f32_bf16 v6, v74, v246, v6
    v_dot2_f32_bf16 v6, v75, v247, v6
    s_nop 2
    s_nop 1
    v_add_f32_dpp v6, v6, v6 row_ror:8 row_mask:0xf bank_mask:0xf
    s_nop 1
    v_add_f32_dpp v6, v6, v6 row_ror:4 row_mask:0xf bank_mask:0xf
    s_nop 1
    v_add_f32_dpp v6, v6, v6 row_ror:2 row_mask:0xf bank_mask:0xf
    s_nop 1
    v_add_f32_dpp v6, v6, v6 row_ror:1 row_mask:0xf bank_mask:0xf
    v_mov_b32 v7, v6
    s_nop 1
    v_permlane16_swap_b32 v7, v6
    s_nop 1
    v_add_f32 v6, v6, v7
    v_mov_b32 v7, v6
    s_nop 1
    v_permlane32_swap_b32 v7, v6
    s_nop 1
    v_add_f32 v6, v6, v7
    v_mul_f32 v6, 0xbfb8aa3b, v6
    v_exp_f32 v6, v6
    s_nop 0
    v_add_f32 v6, 1.0, v6
    v_rcp_f32 v78, v6
    s_nop 0
    v_sub_f32 v79, 1.0, v78
    s_cmp_ge_u32 s31, 27
    s_cbranch_scc1 L_noffn
    s_lshl_b32 s54, s31, 7
    s_add_u32 s40, s16, s54
    s_addc_u32 s41, s17, 0
    s_sub_u32 s42, 2211840, s54
    s_add_u32 s44, s18, s54
    s_addc_u32 s45, s19, 0
    s_mov_b32 s46, s42
    s_mov_b32 s47, 0x20000
    s_mul_i32 s53, s33, 552960
    v_mul_u32_u24 v4, 138240, v2
    v_and_b32 v6, 7, v1
    v_lshl_add_u32 v4, v6, 4, v4
    v_add_u32 v4, s53, v4
    s_mov_b32 exec_lo, 0xff00ff
    s_mov_b32 exec_hi, 0xff00ff
    s_mul_i32 s58, s56, 27648
    s_add_u32 s58, s58, 0
    s_cmp_ge_u32 s58, 138240
    s_cselect_b32 s59, 138240, 0
    s_sub_u32 s58, s58, s59
    buffer_load_dwordx4 v[80:83], v4, s[40:43], s58 offen
    s_mul_i32 s58, s56, 27648
    s_add_u32 s58, s58, 3456
    s_cmp_ge_u32 s58, 138240
    s_cselect_b32 s59, 138240, 0
    s_sub_u32 s58, s58, s59
    buffer_load_dwordx4 v[84:87], v4, s[40:43], s58 offen
    s_mul_i32 s58, s56, 27648
    s_add_u32 s58, s58, 6912
    s_cmp_ge_u32 s58, 138240
    s_cselect_b32 s59, 138240, 0
    s_sub_u32 s58, s58, s59
    buffer_load_dwordx4 v[88:91], v4, s[40:43], s58 offen
    s_mov_b32 exec_lo, 0xff00ff00
    s_mov_b32 exec_hi, 0xff00ff00
    s_mul_i32 s58, s56, 27648
    s_add_u32 s58, s58, 0
    s_cmp_ge_u32 s58, 138240
    s_cselect_b32 s59, 138240, 0
    s_sub_u32 s58, s58, s59
    buffer_load_dwordx4 v[80:83], v4, s[44:47], s58 offen
    s_mul_i32 s58, s56, 27648
    s_add_u32 s58, s58, 3456
    s_cmp_ge_u32 s58, 138240
    s_cselect_b32 s59, 138240, 0
    s_sub_u32 s58, s58, s59
    buffer_load_dwordx4 v[84:87], v4, s[44:47], s58 offen
    s_mul_i32 s58, s56, 27648
    s_add_u32 s58, s58, 6912
    s_cmp_ge_u32 s58, 138240
    s_cselect_b32 s59, 138240, 0
    s_sub_u32 s58, s58, s59
    buffer_load_dwordx4 v[88:91], v4, s[44:47], s58 offen
    s_mov_b64 exec, -1
    s_waitcnt vmcnt(0)
    s_mov_b32 exec_lo, 0xff00ff
    s_mov_b32 exec_hi, 0xff00ff
    s_mul_i32 s58, s56, 27648
    s_add_u32 s58, s58, 10368
    s_cmp_ge_u32 s58, 138240
    s_cselect_b32 s59, 138240, 0
    s_sub_u32 s58, s58, s59
    buffer_load_dwordx4 v[92:95], v4, s[40:43], s58 offen
    s_mul_i32 s58, s56, 27648
    s_add_u32 s58, s58, 13824
    s_cmp_ge_u32 s58, 138240
    s_cselect_b32 s59, 138240, 0
    s_sub_u32 s58, s58, s59
    buffer_load_dwordx4 v[96:99], v4, s[40:43], s58 offen
    s_mul_i32 s58, s56, 27648
    s_add_u32 s58, s58, 17280
    s_cmp_ge_u32 s58, 138240
    s_cselect_b32 s59, 138240, 0
    s_sub_u32 s58, s58, s59
    buffer_load_dwordx4 v[100:103], v4, s[40:43], s58 offen
    s_mov_b32 exec_lo, 0xff00ff00
    s_mov_b32 exec_hi, 0xff00ff00
    s_mul_i32 s58, s56, 27648
    s_add_u32 s58, s58, 10368
    s_cmp_ge_u32 s58, 138240
    s_cselect_b32 s59, 138240, 0
    s_sub_u32 s58, s58, s59
    buffer_load_dwordx4 v[92:95], v4, s[44:47], s58 offen
    s_mul_i32 s58, s56, 27648
    s_add_u32 s58, s58, 13824
    s_cmp_ge_u32 s58, 138240
    s_cselect_b32 s59, 138240, 0
    s_sub_u32 s58, s58, s59
    buffer_load_dwordx4 v[96:99], v4, s[44:47], s58 offen
    s_mul_i32 s58, s56, 27648
    s_add_u32 s58, s58, 17280
    s_cmp_ge_u32 s58, 138240
    s_cselect_b32 s59, 138240, 0
    s_sub_u32 s58, s58, s59
    buffer_load_dwordx4 v[100:103], v4, s[44:47], s58 offen
    s_mov_b64 exec, -1
    s_waitcnt vmcnt(0)
    s_mov_b32 exec_lo, 0xff00ff
    s_mov_b32 exec_hi, 0xff00ff
    s_mul_i32 s58, s56, 27648
    s_add_u32 s58, s58, 20736
    s_cmp_ge_u32 s58, 138240
    s_cselect_b32 s59, 138240, 0
    s_sub_u32 s58, s58, s59
    buffer_load_dwordx4 v[104:107], v4, s[40:43], s58 offen
    s_mul_i32 s58, s56, 27648
    s_add_u32 s58, s58, 24192
    s_cmp_ge_u32 s58, 138240
    s_cselect_b32 s59, 138240, 0
    s_sub_u32 s58, s58, s59
    buffer_load_dwordx4 v[108:111], v4, s[40:43], s58 offen
    s_mul_i32 s58, s56, 27648
    s_add_u32 s58, s58, 27648
    s_cmp_ge_u32 s58, 138240
    s_cselect_b32 s59, 138240, 0
    s_sub_u32 s58, s58, s59
    buffer_load_dwordx4 v[112:115], v4, s[40:43], s58 offen
    s_mov_b32 exec_lo, 0xff00ff00
    s_mov_b32 exec_hi, 0xff00ff00
    s_mul_i32 s58, s56, 27648
    s_add_u32 s58, s58, 20736
    s_cmp_ge_u32 s58, 138240
    s_cselect_b32 s59, 138240, 0
    s_sub_u32 s58, s58, s59
    buffer_load_dwordx4 v[104:107], v4, s[44:47], s58 offen
    s_mul_i32 s58, s56, 27648
    s_add_u32 s58, s58, 24192
    s_cmp_ge_u32 s58, 138240
    s_cselect_b32 s59, 138240, 0
    s_sub_u32 s58, s58, s59
    buffer_load_dwordx4 v[108:111], v4, s[44:47], s58 offen
    s_mul_i32 s58, s56, 27648
    s_add_u32 s58, s58, 27648
    s_cmp_ge_u32 s58, 138240
    s_cselect_b32 s59, 138240, 0
    s_sub_u32 s58, s58, s59
    buffer_load_dwordx4 v[112:115], v4, s[44:47], s58 offen
    s_mov_b64 exec, -1
    s_waitcnt vmcnt(0)
    s_mov_b32 exec_lo, 0xff00ff
    s_mov_b32 exec_hi, 0xff00ff
    s_mul_i32 s58, s56, 27648
    s_add_u32 s58, s58, 31104
    s_cmp_ge_u32 s58, 138240
    s_cselect_b32 s59, 138240, 0
    s_sub_u32 s58, s58, s59
    buffer_load_dwordx4 v[116:119], v4, s[40:43], s58 offen
    s_mul_i32 s58, s56, 27648
    s_add_u32 s58, s58, 34560
    s_cmp_ge_u32 s58, 138240
    s_cselect_b32 s59, 138240, 0
    s_sub_u32 s58, s58, s59
    buffer_load_dwordx4 v[120:123], v4, s[40:43], s58 offen
    s_mul_i32 s58, s56, 27648
    s_add_u32 s58, s58, 38016
    s_cmp_ge_u32 s58, 138240
    s_cselect_b32 s59, 138240, 0
    s_sub_u32 s58, s58, s59
    buffer_load_dwordx4 v[124:127], v4, s[40:43], s58 offen
    s_mov_b32 exec_lo, 0xff00ff00
    s_mov_b32 exec_hi, 0xff00ff00
    s_mul_i32 s58, s56, 27648
    s_add_u32 s58, s58, 31104
    s_cmp_ge_u32 s58, 138240
    s_cselect_b32 s59, 138240, 0
    s_sub_u32 s58, s58, s59
    buffer_load_dwordx4 v[116:119], v4, s[44:47], s58 offen
    s_mul_i32 s58, s56, 27648
    s_add_u32 s58, s58, 34560
    s_cmp_ge_u32 s58, 138240
    s_cselect_b32 s59, 138240, 0
    s_sub_u32 s58, s58, s59
    buffer_load_dwordx4 v[120:123], v4, s[44:47], s58 offen
    s_mul_i32 s58, s56, 27648
    s_add_u32 s58, s58, 38016
    s_cmp_ge_u32 s58, 138240
    s_cselect_b32 s59, 138240, 0
    s_sub_u32 s58, s58, s59
    buffer_load_dwordx4 v[124:127], v4, s[44:47], s58 offen
    s_mov_b64 exec, -1
    s_waitcnt vmcnt(0)
    s_mov_b32 exec_lo, 0xff00ff
    s_mov_b32 exec_hi, 0xff00ff
    s_mul_i32 s58, s56, 27648
    s_add_u32 s58, s58, 41472
    s_cmp_ge_u32 s58, 138240
    s_cselect_b32 s59, 138240, 0
    s_sub_u32 s58, s58, s59
    buffer_load_dwordx4 v[128:131], v4, s[40:43], s58 offen
    s_mul_i32 s58, s56, 27648
    s_add_u32 s58, s58, 44928
    s_cmp_ge_u32 s58, 138240
    s_cselect_b32 s59, 138240, 0
    s_sub_u32 s58, s58, s59
    buffer_load_dwordx4 v[132:135], v4, s[40:43], s58 offen
    s_mul_i32 s58, s56, 27648
    s_add_u32 s58, s58, 48384
    s_cmp_ge_u32 s58, 138240
    s_cselect_b32 s59, 138240, 0
    s_sub_u32 s58, s58, s59
    buffer_load_dwordx4 v[136:139], v4, s[40:43], s58 offen
    s_mov_b32 exec_lo, 0xff00ff00
    s_mov_b32 exec_hi, 0xff00ff00
    s_mul_i32 s58, s56, 27648
    s_add_u32 s58, s58, 41472
    s_cmp_ge_u32 s58, 138240
    s_cselect_b32 s59, 138240, 0
    s_sub_u32 s58, s58, s59
    buffer_load_dwordx4 v[128:131], v4, s[44:47], s58 offen
    s_mul_i32 s58, s56, 27648
    s_add_u32 s58, s58, 44928
    s_cmp_ge_u32 s58, 138240
    s_cselect_b32 s59, 138240, 0
    s_sub_u32 s58, s58, s59
    buffer_load_dwordx4 v[132:135], v4, s[44:47], s58 offen
    s_mul_i32 s58, s56, 27648
    s_add_u32 s58, s58, 48384
    s_cmp_ge_u32 s58, 138240
    s_cselect_b32 s59, 138240, 0
    s_sub_u32 s58, s58, s59
    buffer_load_dwordx4 v[136:139], v4, s[44:47], s58 offen
    s_mov_b64 exec, -1
    s_waitcnt vmcnt(0)
    s_mov_b32 exec_lo, 0xff00ff
    s_mov_b32 exec_hi, 0xff00ff
    s_mul_i32 s58, s56, 27648
    s_add_u32 s58, s58, 51840
    s_cmp_ge_u32 s58, 138240
    s_cselect_b32 s59, 138240, 0
    s_sub_u32 s58, s58, s59
    buffer_load_dwordx4 v[140:143], v4, s[40:43], s58 offen
    s_mul_i32 s58, s56, 27648
    s_add_u32 s58, s58, 55296
    s_cmp_ge_u32 s58, 138240
    s_cselect_b32 s59, 138240, 0
    s_sub_u32 s58, s58, s59
    buffer_load_dwordx4 v[144:147], v4, s[40:43], s58 offen
    s_mul_i32 s58, s56, 27648
    s_add_u32 s58, s58, 58752
    s_cmp_ge_u32 s58, 138240
    s_cselect_b32 s59, 138240, 0
    s_sub_u32 s58, s58, s59
    buffer_load_dwordx4 v[148:151], v4, s[40:43], s58 offen
    s_mov_b32 exec_lo, 0xff00ff00
    s_mov_b32 exec_hi, 0xff00ff00
    s_mul_i32 s58, s56, 27648
    s_add_u32 s58, s58, 51840
    s_cmp_ge_u32 s58, 138240
    s_cselect_b32 s59, 138240, 0
    s_sub_u32 s58, s58, s59
    buffer_load_dwordx4 v[140:143], v4, s[44:47], s58 offen
    s_mul_i32 s58, s56, 27648
    s_add_u32 s58, s58, 55296
    s_cmp_ge_u32 s58, 138240
    s_cselect_b32 s59, 138240, 0
    s_sub_u32 s58, s58, s59
    buffer_load_dwordx4 v[144:147], v4, s[44:47], s58 offen
    s_mul_i32 s58, s56, 27648
    s_add_u32 s58, s58, 58752
    s_cmp_ge_u32 s58, 138240
    s_cselect_b32 s59, 138240, 0
    s_sub_u32 s58, s58, s59
    buffer_load_dwordx4 v[148:151], v4, s[44:47], s58 offen
    s_mov_b64 exec, -1
    s_waitcnt vmcnt(0)
    s_mov_b32 exec_lo, 0xff00ff
    s_mov_b32 exec_hi, 0xff00ff
    s_mul_i32 s58, s56, 27648
    s_add_u32 s58, s58, 62208
    s_cmp_ge_u32 s58, 138240
    s_cselect_b32 s59, 138240, 0
    s_sub_u32 s58, s58, s59
    buffer_load_dwordx4 v[152:155], v4, s[40:43], s58 offen
    s_mul_i32 s58, s56, 27648
    s_add_u32 s58, s58, 65664
    s_cmp_ge_u32 s58, 138240
    s_cselect_b32 s59, 138240, 0
    s_sub_u32 s58, s58, s59
    buffer_load_dwordx4 v[156:159], v4, s[40:43], s58 offen
    s_mul_i32 s58, s56, 27648
    s_add_u32 s58, s58, 69120
    s_cmp_ge_u32 s58, 138240
    s_cselect_b32 s59, 138240, 0
    s_sub_u32 s58, s58, s59
    buffer_load_dwordx4 v[160:163], v4, s[40:43], s58 offen
    s_mov_b32 exec_lo, 0xff00ff00
    s_mov_b32 exec_hi, 0xff00ff00
    s_mul_i32 s58, s56, 27648
    s_add_u32 s58, s58, 62208
    s_cmp_ge_u32 s58, 138240
    s_cselect_b32 s59, 138240, 0
    s_sub_u32 s58, s58, s59
    buffer_load_dwordx4 v[152:155], v4, s[44:47], s58 offen
    s_mul_i32 s58, s56, 27648
    s_add_u32 s58, s58, 65664
    s_cmp_ge_u32 s58, 138240
    s_cselect_b32 s59, 138240, 0
    s_sub_u32 s58, s58, s59
    buffer_load_dwordx4 v[156:159], v4, s[44:47], s58 offen
    s_mul_i32 s58, s56, 27648
    s_add_u32 s58, s58, 69120
    s_cmp_ge_u32 s58, 138240
    s_cselect_b32 s59, 138240, 0
    s_sub_u32 s58, s58, s59
    buffer_load_dwordx4 v[160:163], v4, s[44:47], s58 offen
    s_mov_b64 exec, -1
    s_waitcnt vmcnt(0)
    s_mov_b32 exec_lo, 0xff00ff
    s_mov_b32 exec_hi, 0xff00ff
    s_mul_i32 s58, s56, 27648
    s_add_u32 s58, s58, 72576
    s_cmp_ge_u32 s58, 138240
    s_cselect_b32 s59, 138240, 0
    s_sub_u32 s58, s58, s59
    buffer_load_dwordx4 v[164:167], v4, s[40:43], s58 offen
    s_mul_i32 s58, s56, 27648
    s_add_u32 s58, s58, 76032
    s_cmp_ge_u32 s58, 138240
    s_cselect_b32 s59, 138240, 0
    s_sub_u32 s58, s58, s59
    buffer_load_dwordx4 v[168:171], v4, s[40:43], s58 offen
    s_mul_i32 s58, s56, 27648
    s_add_u32 s58, s58, 79488
    s_cmp_ge_u32 s58, 138240
    s_cselect_b32 s59, 138240, 0
    s_sub_u32 s58, s58, s59
    buffer_load_dwordx4 v[172:175], v4, s[40:43], s58 offen
    s_mov_b32 exec_lo, 0xff00ff00
    s_mov_b32 exec_hi, 0xff00ff00
    s_mul_i32 s58, s56, 27648
    s_add_u32 s58, s58, 72576
    s_cmp_ge_u32 s58, 138240
    s_cselect_b32 s59, 138240, 0
    s_sub_u32 s58, s58, s59
    buffer_load_dwordx4 v[164:167], v4, s[44:47], s58 offen
    s_mul_i32 s58, s56, 27648
    s_add_u32 s58, s58, 76032
    s_cmp_ge_u32 s58, 138240
    s_cselect_b32 s59, 138240, 0
    s_sub_u32 s58, s58, s59
    buffer_load_dwordx4 v[168:171], v4, s[44:47], s58 offen
    s_mul_i32 s58, s56, 27648
    s_add_u32 s58, s58, 79488
    s_cmp_ge_u32 s58, 138240
    s_cselect_b32 s59, 138240, 0
    s_sub_u32 s58, s58, s59
    buffer_load_dwordx4 v[172:175], v4, s[44:47], s58 offen
    s_mov_b64 exec, -1
    s_waitcnt vmcnt(0)
    s_mov_b32 exec_lo, 0xff00ff
    s_mov_b32 exec_hi, 0xff00ff
    s_mul_i32 s58, s56, 27648
    s_add_u32 s58, s58, 82944
    s_cmp_ge_u32 s58, 138240
    s_cselect_b32 s59, 138240, 0
    s_sub_u32 s58, s58, s59
    buffer_load_dwordx4 v[176:179], v4, s[40:43], s58 offen
    s_mul_i32 s58, s56, 27648
    s_add_u32 s58, s58, 86400
    s_cmp_ge_u32 s58, 138240
    s_cselect_b32 s59, 138240, 0
    s_sub_u32 s58, s58, s59
    buffer_load_dwordx4 v[180:183], v4, s[40:43], s58 offen
    s_mul_i32 s58, s56, 27648
    s_add_u32 s58, s58, 89856
    s_cmp_ge_u32 s58, 138240
    s_cselect_b32 s59, 138240, 0
    s_sub_u32 s58, s58, s59
    buffer_load_dwordx4 v[184:187], v4, s[40:43], s58 offen
    s_mov_b32 exec_lo, 0xff00ff00
    s_mov_b32 exec_hi, 0xff00ff00
    s_mul_i32 s58, s56, 27648
    s_add_u32 s58, s58, 82944
    s_cmp_ge_u32 s58, 138240
    s_cselect_b32 s59, 138240, 0
    s_sub_u32 s58, s58, s59
    buffer_load_dwordx4 v[176:179], v4, s[44:47], s58 offen
    s_mul_i32 s58, s56, 27648
    s_add_u32 s58, s58, 86400
    s_cmp_ge_u32 s58, 138240
    s_cselect_b32 s59, 138240, 0
    s_sub_u32 s58, s58, s59
    buffer_load_dwordx4 v[180:183], v4, s[44:47], s58 offen
    s_mul_i32 s58, s56, 27648
    s_add_u32 s58, s58, 89856
    s_cmp_ge_u32 s58, 138240
    s_cselect_b32 s59, 138240, 0
    s_sub_u32 s58, s58, s59
    buffer_load_dwordx4 v[184:187], v4, s[44:47], s58 offen
    s_mov_b64 exec, -1
    s_waitcnt vmcnt(0)
    s_mov_b32 exec_lo, 0xff00ff
    s_mov_b32 exec_hi, 0xff00ff
    s_mul_i32 s58, s56, 27648
    s_add_u32 s58, s58, 93312
    s_cmp_ge_u32 s58, 138240
    s_cselect_b32 s59, 138240, 0
    s_sub_u32 s58, s58, s59
    buffer_load_dwordx4 v[188:191], v4, s[40:43], s58 offen
    s_mul_i32 s58, s56, 27648
    s_add_u32 s58, s58, 96768
    s_cmp_ge_u32 s58, 138240
    s_cselect_b32 s59, 138240, 0
    s_sub_u32 s58, s58, s59
    buffer_load_dwordx4 v[192:195], v4, s[40:43], s58 offen
    s_mul_i32 s58, s56, 27648
    s_add_u32 s58, s58, 100224
    s_cmp_ge_u32 s58, 138240
    s_cselect_b32 s59, 138240, 0
    s_sub_u32 s58, s58, s59
    buffer_load_dwordx4 v[196:199], v4, s[40:43], s58 offen
    s_mov_b32 exec_lo, 0xff00ff00
    s_mov_b32 exec_hi, 0xff00ff00
    s_mul_i32 s58, s56, 27648
    s_add_u32 s58, s58, 93312
    s_cmp_ge_u32 s58, 138240
    s_cselect_b32 s59, 138240, 0
    s_sub_u32 s58, s58, s59
    buffer_load_dwordx4 v[188:191], v4, s[44:47], s58 offen
    s_mul_i32 s58, s56, 27648
    s_add_u32 s58, s58, 96768
    s_cmp_ge_u32 s58, 138240
    s_cselect_b32 s59, 138240, 0
    s_sub_u32 s58, s58, s59
    buffer_load_dwordx4 v[192:195], v4, s[44:47], s58 offen
    s_mul_i32 s58, s56, 27648
    s_add_u32 s58, s58, 100224
    s_cmp_ge_u32 s58, 138240
    s_cselect_b32 s59, 138240, 0
    s_sub_u32 s58, s58, s59
    buffer_load_dwordx4 v[196:199], v4, s[44:47], s58 offen
    s_mov_b64 exec, -1
    s_waitcnt vmcnt(0)
    s_mov_b32 exec_lo, 0xff00ff
    s_mov_b32 exec_hi, 0xff00ff
    s_mul_i32 s58, s56, 27648
    s_add_u32 s58, s58, 103680
    s_cmp_ge_u32 s58, 138240
    s_cselect_b32 s59, 138240, 0
    s_sub_u32 s58, s58, s59
    buffer_load_dwordx4 v[200:203], v4, s[40:43], s58 offen
    s_mul_i32 s58, s56, 27648
    s_add_u32 s58, s58, 107136
    s_cmp_ge_u32 s58, 138240
    s_cselect_b32 s59, 138240, 0
    s_sub_u32 s58, s58, s59
    buffer_load_dwordx4 v[204:207], v4, s[40:43], s58 offen
    s_mul_i32 s58, s56, 27648
    s_add_u32 s58, s58, 110592
    s_cmp_ge_u32 s58, 138240
    s_cselect_b32 s59, 138240, 0
    s_sub_u32 s58, s58, s59
    buffer_load_dwordx4 v[208:211], v4, s[40:43], s58 offen
    s_mov_b32 exec_lo, 0xff00ff00
    s_mov_b32 exec_hi, 0xff00ff00
    s_mul_i32 s58, s56, 27648
    s_add_u32 s58, s58, 103680
    s_cmp_ge_u32 s58, 138240
    s_cselect_b32 s59, 138240, 0
    s_sub_u32 s58, s58, s59
    buffer_load_dwordx4 v[200:203], v4, s[44:47], s58 offen
    s_mul_i32 s58, s56, 27648
    s_add_u32 s58, s58, 107136
    s_cmp_ge_u32 s58, 138240
    s_cselect_b32 s59, 138240, 0
    s_sub_u32 s58, s58, s59
    buffer_load_dwordx4 v[204:207], v4, s[44:47], s58 offen
    s_mul_i32 s58, s56, 27648
    s_add_u32 s58, s58, 110592
    s_cmp_ge_u32 s58, 138240
    s_cselect_b32 s59, 138240, 0
    s_sub_u32 s58, s58, s59
    buffer_load_dwordx4 v[208:211], v4, s[44:47], s58 offen
    s_mov_b64 exec, -1
    s_waitcnt vmcnt(0)
    s_mov_b32 exec_lo, 0xff00ff
    s_mov_b32 exec_hi, 0xff00ff
    s_mul_i32 s58, s56, 27648
    s_add_u32 s58, s58, 114048
    s_cmp_ge_u32 s58, 138240
    s_cselect_b32 s59, 138240, 0
    s_sub_u32 s58, s58, s59
    buffer_load_dwordx4 v[212:215], v4, s[40:43], s58 offen
    s_mul_i32 s58, s56, 27648
    s_add_u32 s58, s58, 117504
    s_cmp_ge_u32 s58, 138240
    s_cselect_b32 s59, 138240, 0
    s_sub_u32 s58, s58, s59
    buffer_load_dwordx4 v[216:219], v4, s[40:43], s58 offen
    s_mul_i32 s58, s56, 27648
    s_add_u32 s58, s58, 120960
    s_cmp_ge_u32 s58, 138240
    s_cselect_b32 s59, 138240, 0
    s_sub_u32 s58, s58, s59
    buffer_load_dwordx4 v[220:223], v4, s[40:43], s58 offen
    s_mov_b32 exec_lo, 0xff00ff00
    s_mov_b32 exec_hi, 0xff00ff00
    s_mul_i32 s58, s56, 27648
    s_add_u32 s58, s58, 114048
    s_cmp_ge_u32 s58, 138240
    s_cselect_b32 s59, 138240, 0
    s_sub_u32 s58, s58, s59
    buffer_load_dwordx4 v[212:215], v4, s[44:47], s58 offen
    s_mul_i32 s58, s56, 27648
    s_add_u32 s58, s58, 117504
    s_cmp_ge_u32 s58, 138240
    s_cselect_b32 s59, 138240, 0
    s_sub_u32 s58, s58, s59
    buffer_load_dwordx4 v[216:219], v4, s[44:47], s58 offen
    s_mul_i32 s58, s56, 27648
    s_add_u32 s58, s58, 120960
    s_cmp_ge_u32 s58, 138240
    s_cselect_b32 s59, 138240, 0
    s_sub_u32 s58, s58, s59
    buffer_load_dwordx4 v[220:223], v4, s[44:47], s58 offen
    s_mov_b64 exec, -1
    s_waitcnt vmcnt(0)
    s_mov_b32 exec_lo, 0xff00ff
    s_mov_b32 exec_hi, 0xff00ff
    s_mul_i32 s58, s56, 27648
    s_add_u32 s58, s58, 124416
    s_cmp_ge_u32 s58, 138240
    s_cselect_b32 s59, 138240, 0
    s_sub_u32 s58, s58, s59
    buffer_load_dwordx4 v[224:227], v4, s[40:43], s58 offen
    s_mul_i32 s58, s56, 27648
    s_add_u32 s58, s58, 127872
    s_cmp_ge_u32 s58, 138240
    s_cselect_b32 s59, 138240, 0
    s_sub_u32 s58, s58, s59
    buffer_load_dwordx4 v[228:231], v4, s[40:43], s58 offen
    s_mul_i32 s58, s56, 27648
    s_add_u32 s58, s58, 131328
    s_cmp_ge_u32 s58, 138240
    s_cselect_b32 s59, 138240, 0
    s_sub_u32 s58, s58, s59
    buffer_load_dwordx4 v[232:235], v4, s[40:43], s58 offen
    s_mov_b32 exec_lo, 0xff00ff00
    s_mov_b32 exec_hi, 0xff00ff00
    s_mul_i32 s58, s56, 27648
    s_add_u32 s58, s58, 124416
    s_cmp_ge_u32 s58, 138240
    s_cselect_b32 s59, 138240, 0
    s_sub_u32 s58, s58, s59
    buffer_load_dwordx4 v[224:227], v4, s[44:47], s58 offen
    s_mul_i32 s58, s56, 27648
    s_add_u32 s58, s58, 127872
    s_cmp_ge_u32 s58, 138240
    s_cselect_b32 s59, 138240, 0
    s_sub_u32 s58, s58, s59
    buffer_load_dwordx4 v[228:231], v4, s[44:47], s58 offen
    s_mul_i32 s58, s56, 27648
    s_add_u32 s58, s58, 131328
    s_cmp_ge_u32 s58, 138240
    s_cselect_b32 s59, 138240, 0
    s_sub_u32 s58, s58, s59
    buffer_load_dwordx4 v[232:235], v4, s[44:47], s58 offen
    s_mov_b64 exec, -1
    s_waitcnt vmcnt(0)
    s_mov_b32 exec_lo, 0xff00ff
    s_mov_b32 exec_hi, 0xff00ff
    s_mul_i32 s58, s56, 27648
    s_add_u32 s58, s58, 134784
    s_cmp_ge_u32 s58, 138240
    s_cselect_b32 s59, 138240, 0
    s_sub_u32 s58, s58, s59
    buffer_load_dwordx4 v[236:239], v4, s[40:43], s58 offen
    s_mov_b32 exec_lo, 0xff00ff00
    s_mov_b32 exec_hi, 0xff00ff00
    s_mul_i32 s58, s56, 27648
    s_add_u32 s58, s58, 134784
    s_cmp_ge_u32 s58, 138240
    s_cselect_b32 s59, 138240, 0
    s_sub_u32 s58, s58, s59
    buffer_load_dwordx4 v[236:239], v4, s[44:47], s58 offen
    s_mov_b64 exec, -1
    s_waitcnt vmcnt(0)
    v_perm_b32 v40, v8, v8, v28
    v_perm_b32 v41, v8, v8, v29
    v_perm_b32 v42, v8, v8, v30
    v_perm_b32 v43, v8, v8, v31
    v_perm_b32 v44, v8, v8, v32
    v_perm_b32 v45, v8, v8, v33
    v_perm_b32 v46, v8, v8, v34
    v_perm_b32 v47, v8, v8, v35
    v_mfma_f32_16x16x32_bf16 v[48:51], v[80:83], v[40:43], 0
    v_perm_b32 v40, v9, v9, v28
    v_perm_b32 v41, v9, v9, v29
    v_perm_b32 v42, v9, v9, v30
    v_perm_b32 v43, v9, v9, v31
    v_mfma_f32_16x16x32_bf16 v[48:51], v[84:87], v[44:47], v[48:51]
    v_perm_b32 v44, v9, v9, v32
    v_perm_b32 v45, v9, v9, v33
    v_perm_b32 v46, v9, v9, v34
    v_perm_b32 v47, v9, v9, v35
    v_mfma_f32_16x16x32_bf16 v[48:51], v[88:91], v[40:43], v[48:51]
    v_perm_b32 v40, v10, v10, v28
    v_perm_b32 v41, v10, v10, v29
    v_perm_b32 v42, v10, v10, v30
    v_perm_b32 v43, v10, v10, v31
    v_mfma_f32_16x16x32_bf16 v[48:51], v[92:95], v[44:47], v[48:51]
    v_perm_b32 v44, v10, v10, v32
    v_perm_b32 v45, v10, v10, v33
    v_perm_b32 v46, v10, v10, v34
    v_perm_b32 v47, v10, v10, v35
    v_mfma_f32_16x16x32_bf16 v[48:51], v[96:99], v[40:43], v[48:51]
    v_perm_b32 v40, v11, v11, v28
    v_perm_b32 v41, v11, v11, v29
    v_perm_b32 v42, v11, v11, v30
    v_perm_b32 v43, v11, v11, v31
    v_mfma_f32_16x16x32_bf16 v[48:51], v[100:103], v[44:47], v[48:51]
    v_perm_b32 v44, v11, v11, v32
    v_perm_b32 v45, v11, v11, v33
    v_perm_b32 v46, v11, v11, v34
    v_perm_b32 v47, v11, v11, v35
    v_mfma_f32_16x16x32_bf16 v[48:51], v[104:107], v[40:43], v[48:51]
    v_perm_b32 v40, v12, v12, v28
    v_perm_b32 v41, v12, v12, v29
    v_perm_b32 v42, v12, v12, v30
    v_perm_b32 v43, v12, v12, v31
    v_mfma_f32_16x16x32_bf16 v[48:51], v[108:111], v[44:47], v[48:51]
    v_perm_b32 v44, v12, v12, v32
    v_perm_b32 v45, v12, v12, v33
    v_perm_b32 v46, v12, v12, v34
    v_perm_b32 v47, v12, v12, v35
    v_mfma_f32_16x16x32_bf16 v[48:51], v[112:115], v[40:43], v[48:51]
    v_perm_b32 v40, v13, v13, v28
    v_perm_b32 v41, v13, v13, v29
    v_perm_b32 v42, v13, v13, v30
    v_perm_b32 v43, v13, v13, v31
    v_mfma_f32_16x16x32_bf16 v[48:51], v[116:119], v[44:47], v[48:51]
    v_perm_b32 v44, v13, v13, v32
    v_perm_b32 v45, v13, v13, v33
    v_perm_b32 v46, v13, v13, v34
    v_perm_b32 v47, v13, v13, v35
    v_mfma_f32_16x16x32_bf16 v[48:51], v[120:123], v[40:43], v[48:51]
    v_perm_b32 v40, v14, v14, v28
    v_perm_b32 v41, v14, v14, v29
    v_perm_b32 v42, v14, v14, v30
    v_perm_b32 v43, v14, v14, v31
    v_mfma_f32_16x16x32_bf16 v[48:51], v[124:127], v[44:47], v[48:51]
    v_perm_b32 v44, v14, v14, v32
    v_perm_b32 v45, v14, v14, v33
    v_perm_b32 v46, v14, v14, v34
    v_perm_b32 v47, v14, v14, v35
    v_mfma_f32_16x16x32_bf16 v[48:51], v[128:131], v[40:43], v[48:51]
    v_perm_b32 v40, v15, v15, v28
    v_perm_b32 v41, v15, v15, v29
    v_perm_b32 v42, v15, v15, v30
    v_perm_b32 v43, v15, v15, v31
    v_mfma_f32_16x16x32_bf16 v[48:51], v[132:135], v[44:47], v[48:51]
    v_perm_b32 v44, v15, v15, v32
    v_perm_b32 v45, v15, v15, v33
    v_perm_b32 v46, v15, v15, v34
    v_perm_b32 v47, v15, v15, v35
    v_mfma_f32_16x16x32_bf16 v[48:51], v[136:139], v[40:43], v[48:51]
    v_perm_b32 v40, v16, v16, v28
    v_perm_b32 v41, v16, v16, v29
    v_perm_b32 v42, v16, v16, v30
    v_perm_b32 v43, v16, v16, v31
    v_mfma_f32_16x16x32_bf16 v[48:51], v[140:143], v[44:47], v[48:51]
    v_perm_b32 v44, v16, v16, v32
    v_perm_b32 v45, v16, v16, v33
    v_perm_b32 v46, v16, v16, v34
    v_perm_b32 v47, v16, v16, v35
    v_mfma_f32_16x16x32_bf16 v[48:51], v[144:147], v[40:43], v[48:51]
    v_perm_b32 v40, v17, v17, v28
    v_perm_b32 v41, v17, v17, v29
    v_perm_b32 v42, v17, v17, v30
    v_perm_b32 v43, v17, v17, v31
    v_mfma_f32_16x16x32_bf16 v[48:51], v[148:151], v[44:47], v[48:51]
    v_perm_b32 v44, v17, v17, v32
    v_perm_b32 v45, v17, v17, v33
    v_perm_b32 v46, v17, v17, v34
    v_perm_b32 v47, v17, v17, v35
    v_mfma_f32_16x16x32_bf16 v[48:51], v[152:155], v[40:43], v[48:51]
    v_perm_b32 v40, v18, v18, v28
    v_perm_b32 v41, v18, v18, v29
    v_perm_b32 v42, v18, v18, v30
    v_perm_b32 v43, v18, v18, v31
    v_mfma_f32_16x16x32_bf16 v[48:51], v[156:159], v[44:47], v[48:51]
    v_perm_b32 v44, v18, v18, v32
    v_perm_b32 v45, v18, v18, v33
    v_perm_b32 v46, v18, v18, v34
    v_perm_b32 v47, v18, v18, v35
    v_mfma_f32_16x16x32_bf16 v[48:51], v[160:163], v[40:43], v[48:51]
    v_perm_b32 v40, v19, v19, v28
    v_perm_b32 v41, v19, v19, v29
    v_perm_b32 v42, v19, v19, v30
    v_perm_b32 v43, v19, v19, v31
    v_mfma_f32_16x16x32_bf16 v[48:51], v[164:167], v[44:47], v[48:51]
    v_perm_b32 v44, v19, v19, v32
    v_perm_b32 v45, v19, v19, v33
    v_perm_b32 v46, v19, v19, v34
    v_perm_b32 v47, v19, v19, v35
    v_mfma_f32_16x16x32_bf16 v[48:51], v[168:171], v[40:43], v[48:51]
    v_perm_b32 v40, v20, v20, v28
    v_perm_b32 v41, v20, v20, v29
    v_perm_b32 v42, v20, v20, v30
    v_perm_b32 v43, v20, v20, v31
    v_mfma_f32_16x16x32_bf16 v[48:51], v[172:175], v[44:47], v[48:51]
    v_perm_b32 v44, v20, v20, v32
    v_perm_b32 v45, v20, v20, v33
    v_perm_b32 v46, v20, v20, v34
    v_perm_b32 v47, v20, v20, v35
    v_mfma_f32_16x16x32_bf16 v[48:51], v[176:179], v[40:43], v[48:51]
    v_perm_b32 v40, v21, v21, v28
    v_perm_b32 v41, v21, v21, v29
    v_perm_b32 v42, v21, v21, v30
    v_perm_b32 v43, v21, v21, v31
    v_mfma_f32_16x16x32_bf16 v[48:51], v[180:183], v[44:47], v[48:51]
    v_perm_b32 v44, v21, v21, v32
    v_perm_b32 v45, v21, v21, v33
    v_perm_b32 v46, v21, v21, v34
    v_perm_b32 v47, v21, v21, v35
    v_mfma_f32_16x16x32_bf16 v[48:51], v[184:187], v[40:43], v[48:51]
    v_perm_b32 v40, v22, v22, v28
    v_perm_b32 v41, v22, v22, v29
    v_perm_b32 v42, v22, v22, v30
    v_perm_b32 v43, v22, v22, v31
    v_mfma_f32_16x16x32_bf16 v[48:51], v[188:191], v[44:47], v[48:51]
    v_perm_b32 v44, v22, v22, v32
    v_perm_b32 v45, v22, v22, v33
    v_perm_b32 v46, v22, v22, v34
    v_perm_b32 v47, v22, v22, v35
    v_mfma_f32_16x16x32_bf16 v[48:51], v[192:195], v[40:43], v[48:51]
    v_perm_b32 v40, v23, v23, v28
    v_perm_b32 v41, v23, v23, v29
    v_perm_b32 v42, v23, v23, v30
    v_perm_b32 v43, v23, v23, v31
    v_mfma_f32_16x16x32_bf16 v[48:51], v[196:199], v[44:47], v[48:51]
    v_perm_b32 v44, v23, v23, v32
    v_perm_b32 v45, v23, v23, v33
    v_perm_b32 v46, v23, v23, v34
    v_perm_b32 v47, v23, v23, v35
    v_mfma_f32_16x16x32_bf16 v[48:51], v[200:203], v[40:43], v[48:51]
    v_perm_b32 v40, v24, v24, v28
    v_perm_b32 v41, v24, v24, v29
    v_perm_b32 v42, v24, v24, v30
    v_perm_b32 v43, v24, v24, v31
    v_mfma_f32_16x16x32_bf16 v[48:51], v[204:207], v[44:47], v[48:51]
    v_perm_b32 v44, v24, v24, v32
    v_perm_b32 v45, v24, v24, v33
    v_perm_b32 v46, v24, v24, v34
    v_perm_b32 v47, v24, v24, v35
    v_mfma_f32_16x16x32_bf16 v[48:51], v[208:211], v[40:43], v[48:51]
    v_perm_b32 v40, v25, v25, v28
    v_perm_b32 v41, v25, v25, v29
    v_perm_b32 v42, v25, v25, v30
    v_perm_b32 v43, v25, v25, v31
    v_mfma_f32_16x16x32_bf16 v[48:51], v[212:215], v[44:47], v[48:51]
    v_perm_b32 v44, v25, v25, v32
    v_perm_b32 v45, v25, v25, v33
    v_perm_b32 v46, v25, v25, v34
    v_perm_b32 v47, v25, v25, v35
    v_mfma_f32_16x16x32_bf16 v[48:51], v[216:219], v[40:43], v[48:51]
    v_perm_b32 v40, v26, v26, v28
    v_perm_b32 v41, v26, v26, v29
    v_perm_b32 v42, v26, v26, v30
    v_perm_b32 v43, v26, v26, v31
    v_mfma_f32_16x16x32_bf16 v[48:51], v[220:223], v[44:47], v[48:51]
    v_perm_b32 v44, v26, v26, v32
    v_perm_b32 v45, v26, v26, v33
    v_perm_b32 v46, v26, v26, v34
    v_perm_b32 v47, v26, v26, v35
    v_mfma_f32_16x16x32_bf16 v[48:51], v[224:227], v[40:43], v[48:51]
    v_perm_b32 v40, v27, v27, v28
    v_perm_b32 v41, v27, v27, v29
    v_perm_b32 v42, v27, v27, v30
    v_perm_b32 v43, v27, v27, v31
    v_mfma_f32_16x16x32_bf16 v[48:51], v[228:231], v[44:47], v[48:51]
    v_perm_b32 v44, v27, v27, v32
    v_perm_b32 v45, v27, v27, v33
    v_perm_b32 v46, v27, v27, v34
    v_perm_b32 v47, v27, v27, v35
    v_mfma_f32_16x16x32_bf16 v[48:51], v[232:235], v[40:43], v[48:51]
    s_nop 1
    v_mfma_f32_16x16x32_bf16 v[48:51], v[236:239], v[44:47], v[48:51]
    s_mul_i32 s54, s31, 81920
    s_add_u32 s40, s20, s54
    s_addc_u32 s41, s21, 0
    s_mov_b32 s42, 81920
    s_mul_i32 s53, s33, 20480
    v_mul_u32_u24 v4, 5120, v2
    v_lshl_add_u32 v4, v1, 4, v4
    v_add_u32 v4, s53, v4
    s_mov_b32 s55, 0
    buffer_load_dwordx4 v[80:83], v4, s[40:43], s55 offen offset:0
    buffer_load_dwordx4 v[84:87], v4, s[40:43], s55 offen offset:256
    s_waitcnt vmcnt(0)
    buffer_load_dwordx4 v[88:91], v4, s[40:43], s55 offen offset:512
    buffer_load_dwordx4 v[92:95], v4, s[40:43], s55 offen offset:768
    s_waitcnt vmcnt(0)
    buffer_load_dwordx4 v[96:99], v4, s[40:43], s55 offen offset:1024
    s_mov_b32 s55, 1280
    buffer_load_dwordx4 v[100:103], v4, s[40:43], s55 offen offset:0
    s_waitcnt vmcnt(0)
    buffer_load_dwordx4 v[104:107], v4, s[40:43], s55 offen offset:256
    buffer_load_dwordx4 v[108:111], v4, s[40:43], s55 offen offset:512
    s_waitcnt vmcnt(0)
    buffer_load_dwordx4 v[112:115], v4, s[40:43], s55 offen offset:768
    buffer_load_dwordx4 v[116:119], v4, s[40:43], s55 offen offset:1024
    s_waitcnt vmcnt(0)
    s_mov_b32 s55, 2560
    buffer_load_dwordx4 v[120:123], v4, s[40:43], s55 offen offset:0
    buffer_load_dwordx4 v[124:127], v4, s[40:43], s55 offen offset:256
    s_waitcnt vmcnt(0)
    buffer_load_dwordx4 v[128:131], v4, s[40:43], s55 offen offset:512
    buffer_load_dwordx4 v[132:135], v4, s[40:43], s55 offen offset:768
    s_waitcnt vmcnt(0)
    buffer_load_dwordx4 v[136:139], v4, s[40:43], s55 offen offset:1024
    s_mov_b32 s55, 3840
    buffer_load_dwordx4 v[140:143], v4, s[40:43], s55 offen offset:0
    s_waitcnt vmcnt(0)
    buffer_load_dwordx4 v[144:147], v4, s[40:43], s55 offen offset:256
    buffer_load_dwordx4 v[148:151], v4, s[40:43], s55 offen offset:512
    s_waitcnt vmcnt(0)
    buffer_load_dwordx4 v[152:155], v4, s[40:43], s55 offen offset:768
    buffer_load_dwordx4 v[156:159], v4, s[40:43], s55 offen offset:1024
    s_waitcnt vmcnt(0)
    s_mov_b32 exec_lo, 0x00ff00ff
    s_mov_b32 exec_hi, 0x00ff00ff
    ds_write_b32 v5, v48 offset:18432
    ds_write_b32 v5, v49 offset:18464
    ds_write_b32 v5, v50 offset:18496
    ds_write_b32 v5, v51 offset:18528
    s_waitcnt lgkmcnt(0)
    s_mov_b64 exec, -1
    v_mov_b32 v6, 1
    v_mov_b32 v7, 22592
    s_mov_b64 exec, 1
    ds_add_u32 v7, v6
    s_mov_b64 exec, -1
L_spin:
    ds_read_b32 v6, v7
    s_waitcnt lgkmcnt(0)
    v_readfirstlane_b32 s55, v6
    s_nop 3
    s_cmp_ge_u32 s55, 4
    s_cbranch_scc1 L_spun
    s_sleep 2
    s_branch L_spin
L_spun:
    s_lshl_b32 s55, s33, 6
    v_lshlrev_b32 v6, 4, v2
    v_add_u32 v6, s55, v6
    ds_read_b128 v[8:11], v6 offset:18432
    ds_read_b128 v[12:15], v6 offset:18688
    ds_read_b128 v[16:19], v6 offset:18944
    ds_read_b128 v[20:23], v6 offset:19200
    s_waitcnt lgkmcnt(0)
    v_add_f32 v8, v8, v16
    v_add_f32 v9, v9, v17
    v_add_f32 v10, v10, v18
    v_add_f32 v11, v11, v19
    v_add_f32 v12, v12, v20
    v_add_f32 v13, v13, v21
    v_add_f32 v14, v14, v22
    v_add_f32 v15, v15, v23
    ds_read_b128 v[16:19], v6 offset:19456
    ds_read_b128 v[20:23], v6 offset:19712
    s_waitcnt lgkmcnt(0)
    v_add_f32 v8, v8, v16
    v_add_f32 v9, v9, v17
    v_add_f32 v10, v10, v18
    v_add_f32 v11, v11, v19
    v_add_f32 v12, v12, v20
    v_add_f32 v13, v13, v21
    v_add_f32 v14, v14, v22
    v_add_f32 v15, v15, v23
    ds_read_b128 v[16:19], v6 offset:19968
    ds_read_b128 v[20:23], v6 offset:20224
    s_waitcnt lgkmcnt(0)
    v_add_f32 v8, v8, v16
    v_add_f32 v9, v9, v17
    v_add_f32 v10, v10, v18
    v_add_f32 v11, v11, v19
    v_add_f32 v12, v12, v20
    v_add_f32 v13, v13, v21
    v_add_f32 v14, v14, v22
    v_add_f32 v15, v15, v23
    v_max_f32 v8, 0, v8
    v_max_f32 v9, 0, v9
    v_max_f32 v10, 0, v10
    v_max_f32 v11, 0, v11
    v_mul_f32 v8, v8, v12
    v_mul_f32 v9, v9, v13
    v_mul_f32 v10, v10, v14
    v_mul_f32 v11, v11, v15
    v_cvt_pk_bf16_f32 v8, v8, v8
    v_cvt_pk_bf16_f32 v9, v9, v9
    v_cvt_pk_bf16_f32 v10, v10, v10
    v_cvt_pk_bf16_f32 v11, v11, v11
    s_waitcnt vmcnt(0)
    v_and_b32 v40, v8, v36
    v_and_b32 v41, v8, v37
    v_and_b32 v42, v8, v38
    v_and_b32 v43, v8, v39
    s_nop 1
    v_mfma_f32_16x16x32_bf16 v[48:51], v[80:83], v[40:43], 0
    v_mfma_f32_16x16x32_bf16 v[52:55], v[84:87], v[40:43], 0
    v_mfma_f32_16x16x32_bf16 v[56:59], v[88:91], v[40:43], 0
    v_mfma_f32_16x16x32_bf16 v[60:63], v[92:95], v[40:43], 0
    v_mfma_f32_16x16x32_bf16 v[64:67], v[96:99], v[40:43], 0
    v_and_b32 v44, v9, v36
    v_and_b32 v45, v9, v37
    v_and_b32 v46, v9, v38
    v_and_b32 v47, v9, v39
    s_nop 1
    v_mfma_f32_16x16x32_bf16 v[48:51], v[100:103], v[44:47], v[48:51]
    v_mfma_f32_16x16x32_bf16 v[52:55], v[104:107], v[44:47], v[52:55]
    v_mfma_f32_16x16x32_bf16 v[56:59], v[108:111], v[44:47], v[56:59]
    v_mfma_f32_16x16x32_bf16 v[60:63], v[112:115], v[44:47], v[60:63]
    v_mfma_f32_16x16x32_bf16 v[64:67], v[116:119], v[44:47], v[64:67]
    v_and_b32 v40, v10, v36
    v_and_b32 v41, v10, v37
    v_and_b32 v42, v10, v38
    v_and_b32 v43, v10, v39
    s_nop 1
    v_mfma_f32_16x16x32_bf16 v[48:51], v[120:123], v[40:43], v[48:51]
    v_mfma_f32_16x16x32_bf16 v[52:55], v[124:127], v[40:43], v[52:55]
    v_mfma_f32_16x16x32_bf16 v[56:59], v[128:131], v[40:43], v[56:59]
    v_mfma_f32_16x16x32_bf16 v[60:63], v[132:135], v[40:43], v[60:63]
    v_mfma_f32_16x16x32_bf16 v[64:67], v[136:139], v[40:43], v[64:67]
    v_and_b32 v44, v11, v36
    v_and_b32 v45, v11, v37
    v_and_b32 v46, v11, v38
    v_and_b32 v47, v11, v39
    s_nop 1
    v_mfma_f32_16x16x32_bf16 v[48:51], v[140:143], v[44:47], v[48:51]
    v_mfma_f32_16x16x32_bf16 v[52:55], v[144:147], v[44:47], v[52:55]
    v_mfma_f32_16x16x32_bf16 v[56:59], v[148:151], v[44:47], v[56:59]
    v_mfma_f32_16x16x32_bf16 v[60:63], v[152:155], v[44:47], v[60:63]
    v_mfma_f32_16x16x32_bf16 v[64:67], v[156:159], v[44:47], v[64:67]
    s_nop 7
    s_nop 1
    v_mul_f32 v48, v79, v48
    v_mul_f32 v49, v79, v49
    v_mul_f32 v50, v79, v50
    v_mul_f32 v51, v79, v51
    v_mul_f32 v52, v79, v52
    v_mul_f32 v53, v79, v53
    v_mul_f32 v54, v79, v54
    v_mul_f32 v55, v79, v55
    v_mul_f32 v56, v79, v56
    v_mul_f32 v57, v79, v57
    v_mul_f32 v58, v79, v58
    v_mul_f32 v59, v79, v59
    v_mul_f32 v60, v79, v60
    v_mul_f32 v61, v79, v61
    v_mul_f32 v62, v79, v62
    v_mul_f32 v63, v79, v63
    v_mul_f32 v64, v79, v64
    v_mul_f32 v65, v79, v65
    v_mul_f32 v66, v79, v66
    v_mul_f32 v67, v79, v67
    s_branch L_ffndone
L_noffn:
    v_mov_b32 v48, 0
    v_mov_b32 v49, 0
    v_mov_b32 v50, 0
    v_mov_b32 v51, 0
    v_mov_b32 v52, 0
    v_mov_b32 v53, 0
    v_mov_b32 v54, 0
    v_mov_b32 v55, 0
    v_mov_b32 v56, 0
    v_mov_b32 v57, 0
    v_mov_b32 v58, 0
    v_mov_b32 v59, 0
    v_mov_b32 v60, 0
    v_mov_b32 v61, 0
    v_mov_b32 v62, 0
    v_mov_b32 v63, 0
    v_mov_b32 v64, 0
    v_mov_b32 v65, 0
    v_mov_b32 v66, 0
    v_mov_b32 v67, 0
L_ffndone:
    v_mov_b32 v7, 0
    s_cmp_eq_u32 s33, 0
    s_cbranch_scc0 L_norank
    v_mov_b32 v8, 22592
L_kwait0:
    ds_read_b32 v9, v8 offset:4
    s_waitcnt lgkmcnt(0)
    v_readfirstlane_b32 s55, v9
    s_nop 3
    s_cmp_ge_u32 s55, 4
    s_cbranch_scc1 L_kready0
    s_sleep 8
    s_branch L_kwait0
L_kready0:
    s_mov_b32 s44, s26
    s_mov_b32 s45, s27
    s_mov_b32 s46, 256
    s_mov_b32 s47, 0x20000
    v_mov_b32 v9, 16
    v_mov_b32 v10, 1
    s_mov_b64 exec, 1
    buffer_atomic_add v10, v9, s[44:47], 0 offen sc0
    s_waitcnt vmcnt(0)
    v_readfirstlane_b32 s55, v10
    s_nop 3
    s_mov_b32 s54, 65
    s_cmp_lt_u32 s55, 224
    s_cselect_b32 s54, 1089, s54
    s_cmp_lt_u32 s55, 192
    s_cselect_b32 s54, 1857, s54
    s_cmp_lt_u32 s55, 160
    s_cselect_b32 s54, 2369, s54
    s_cmp_lt_u32 s55, 128
    s_cselect_b32 s54, 2625, s54
    s_cmp_lt_u32 s55, 96
    s_cselect_b32 s54, 2881, s54
    s_cmp_lt_u32 s55, 64
    s_cselect_b32 s54, 3137, s54
    s_cmp_lt_u32 s55, 32
    s_cselect_b32 s54, 3393, s54
    s_mov_b32 s59, s54
    v_mov_b32 v10, s54
    ds_write_b32 v8, v10 offset:8
    s_mov_b64 exec, -1
L_norank:
    v_mov_b32 v16, 22592
L_mlwait:
    ds_read_b32 v17, v16 offset:4
    s_waitcnt lgkmcnt(0)
    v_readfirstlane_b32 s55, v17
    s_nop 3
    s_cmp_ge_u32 s55, 4
    s_cbranch_scc1 L_mlready
    s_sleep 8
    s_branch L_mlwait
L_mlready:
    ds_read_b128 v[8:11], v7 offset:22528
    ds_read_b128 v[12:15], v7 offset:22544
    s_waitcnt lgkmcnt(0)
    v_max3_f32 v24, v8, v10, v12
    v_max_f32 v24, v24, v14
    s_mov_b32 s55, 0x3e0293ee
    v_sub_f32 v8, v8, v24
    v_sub_f32 v10, v10, v24
    v_sub_f32 v12, v12, v24
    v_sub_f32 v14, v14, v24
    v_mul_f32 v8, s55, v8
    v_mul_f32 v10, s55, v10
    v_mul_f32 v12, s55, v12
    v_mul_f32 v14, s55, v14
    v_exp_f32 v8, v8
    v_exp_f32 v10, v10
    v_exp_f32 v12, v12
    v_exp_f32 v14, v14
    s_nop 0
    v_mul_f32 v25, v8, v9
    v_fmac_f32 v25, v10, v11
    v_fmac_f32 v25, v12, v13
    v_fmac_f32 v25, v14, v15
    v_rcp_f32 v25, v25
    s_nop 0
    v_mul_f32 v25, v25, v78
    v_mul_f32 v8, v8, v25
    v_mul_f32 v10, v10, v25
    v_mul_f32 v12, v12, v25
    v_mul_f32 v14, v14, v25
    s_mul_i32 s54, s31, 163840
    s_add_u32 s40, s12, s54
    s_addc_u32 s41, s13, 0
    s_mov_b32 s42, 163840
    s_mov_b32 s43, 0x20000
    s_mul_i32 s53, s33, 40960
    v_mul_u32_u24 v4, 10240, v2
    v_lshl_add_u32 v4, v1, 4, v4
    v_add_u32 v4, s53, v4
    s_mov_b32 s55, 0
    buffer_load_dwordx4 v[80:83], v4, s[40:43], s55 offen offset:0
    buffer_load_dwordx4 v[84:87], v4, s[40:43], s55 offen offset:256
    s_waitcnt vmcnt(0)
    buffer_load_dwordx4 v[88:91], v4, s[40:43], s55 offen offset:512
    buffer_load_dwordx4 v[92:95], v4, s[40:43], s55 offen offset:768
    s_waitcnt vmcnt(0)
    buffer_load_dwordx4 v[96:99], v4, s[40:43], s55 offen offset:1024
    s_mov_b32 s55, 1280
    buffer_load_dwordx4 v[100:103], v4, s[40:43], s55 offen offset:0
    s_waitcnt vmcnt(0)
    buffer_load_dwordx4 v[104:107], v4, s[40:43], s55 offen offset:256
    buffer_load_dwordx4 v[108:111], v4, s[40:43], s55 offen offset:512
    s_waitcnt vmcnt(0)
    buffer_load_dwordx4 v[112:115], v4, s[40:43], s55 offen offset:768
    buffer_load_dwordx4 v[116:119], v4, s[40:43], s55 offen offset:1024
    s_waitcnt vmcnt(0)
    s_mov_b32 s55, 2560
    buffer_load_dwordx4 v[120:123], v4, s[40:43], s55 offen offset:0
    buffer_load_dwordx4 v[124:127], v4, s[40:43], s55 offen offset:256
    s_waitcnt vmcnt(0)
    buffer_load_dwordx4 v[128:131], v4, s[40:43], s55 offen offset:512
    buffer_load_dwordx4 v[132:135], v4, s[40:43], s55 offen offset:768
    s_waitcnt vmcnt(0)
    buffer_load_dwordx4 v[136:139], v4, s[40:43], s55 offen offset:1024
    s_mov_b32 s55, 3840
    buffer_load_dwordx4 v[140:143], v4, s[40:43], s55 offen offset:0
    s_waitcnt vmcnt(0)
    buffer_load_dwordx4 v[144:147], v4, s[40:43], s55 offen offset:256
    buffer_load_dwordx4 v[148:151], v4, s[40:43], s55 offen offset:512
    s_waitcnt vmcnt(0)
    buffer_load_dwordx4 v[152:155], v4, s[40:43], s55 offen offset:768
    buffer_load_dwordx4 v[156:159], v4, s[40:43], s55 offen offset:1024
    s_waitcnt vmcnt(0)
    s_mov_b32 s55, 5120
    buffer_load_dwordx4 v[160:163], v4, s[40:43], s55 offen offset:0
    buffer_load_dwordx4 v[164:167], v4, s[40:43], s55 offen offset:256
    s_waitcnt vmcnt(0)
    buffer_load_dwordx4 v[168:171], v4, s[40:43], s55 offen offset:512
    buffer_load_dwordx4 v[172:175], v4, s[40:43], s55 offen offset:768
    s_waitcnt vmcnt(0)
    buffer_load_dwordx4 v[176:179], v4, s[40:43], s55 offen offset:1024
    s_mov_b32 s55, 6400
    buffer_load_dwordx4 v[180:183], v4, s[40:43], s55 offen offset:0
    s_waitcnt vmcnt(0)
    buffer_load_dwordx4 v[184:187], v4, s[40:43], s55 offen offset:256
    buffer_load_dwordx4 v[188:191], v4, s[40:43], s55 offen offset:512
    s_waitcnt vmcnt(0)
    buffer_load_dwordx4 v[192:195], v4, s[40:43], s55 offen offset:768
    buffer_load_dwordx4 v[196:199], v4, s[40:43], s55 offen offset:1024
    s_waitcnt vmcnt(0)
    s_mov_b32 s55, 7680
    buffer_load_dwordx4 v[200:203], v4, s[40:43], s55 offen offset:0
    buffer_load_dwordx4 v[204:207], v4, s[40:43], s55 offen offset:256
    s_waitcnt vmcnt(0)
    buffer_load_dwordx4 v[208:211], v4, s[40:43], s55 offen offset:512
    buffer_load_dwordx4 v[212:215], v4, s[40:43], s55 offen offset:768
    s_waitcnt vmcnt(0)
    buffer_load_dwordx4 v[216:219], v4, s[40:43], s55 offen offset:1024
    s_mov_b32 s55, 8960
    buffer_load_dwordx4 v[220:223], v4, s[40:43], s55 offen offset:0
    s_waitcnt vmcnt(0)
    buffer_load_dwordx4 v[224:227], v4, s[40:43], s55 offen offset:256
    buffer_load_dwordx4 v[228:231], v4, s[40:43], s55 offen offset:512
    s_waitcnt vmcnt(0)
    buffer_load_dwordx4 v[232:235], v4, s[40:43], s55 offen offset:768
    buffer_load_dwordx4 v[236:239], v4, s[40:43], s55 offen offset:1024
    s_waitcnt vmcnt(0)
    s_lshl_b32 s55, s33, 7
    v_lshlrev_b32 v6, 5, v2
    v_add_u32 v6, s55, v6
    v_mov_b32 v7, 0
    s_mul_i32 s55, s33, 2560
    v_lshlrev_b32 v5, 7, v2
    v_lshl_or_b32 v5, v1, 2, v5
    v_add_u32 v5, s55, v5
    s_waitcnt vmcnt(0)
    s_cmp_eq_u32 s33, 2
    s_cbranch_scc0 L_nocpf
    v_lshlrev_b32 v16, 6, v0
    s_add_u32 s64, s66, L_htail-L_pc0
    s_addc_u32 s65, s67, 0
    global_load_dword v17, v16, s[64:65]
    s_add_u32 s64, s66, L_vtail-L_pc0
    s_addc_u32 s65, s67, 0
    global_load_dword v18, v16, s[64:65]
    s_add_u32 s64, s64, 4096
    s_addc_u32 s65, s65, 0
    global_load_dword v19, v16, s[64:65]
    s_waitcnt vmcnt(0)
L_nocpf:
    s_setprio 2
    s_barrier
L_htail:
    ds_read_b128 v[16:19], v6 offset:20480
    ds_read_b128 v[20:23], v6 offset:20496
    ds_read_b128 v[240:243], v6 offset:20992
    ds_read_b128 v[244:247], v6 offset:21008
    ds_read_b128 v[248:251], v6 offset:21504
    ds_read_b128 v[252:255], v6 offset:21520
    ds_read_b128 v[28:31], v6 offset:22016
    ds_read_b128 v[32:35], v6 offset:22032
    s_waitcnt lgkmcnt(0)
    v_mul_f32 v68, v8, v16
    v_mul_f32 v69, v8, v17
    v_mul_f32 v70, v8, v18
    v_mul_f32 v71, v8, v19
    v_mul_f32 v72, v8, v20
    v_mul_f32 v73, v8, v21
    v_mul_f32 v74, v8, v22
    v_mul_f32 v75, v8, v23
    v_fmac_f32 v68, v10, v240
    v_fmac_f32 v69, v10, v241
    v_fmac_f32 v70, v10, v242
    v_fmac_f32 v71, v10, v243
    v_fmac_f32 v72, v10, v244
    v_fmac_f32 v73, v10, v245
    v_fmac_f32 v74, v10, v246
    v_fmac_f32 v75, v10, v247
    v_fmac_f32 v68, v12, v248
    v_fmac_f32 v69, v12, v249
    v_fmac_f32 v70, v12, v250
    v_fmac_f32 v71, v12, v251
    v_fmac_f32 v72, v12, v252
    v_fmac_f32 v73, v12, v253
    v_fmac_f32 v74, v12, v254
    v_fmac_f32 v75, v12, v255
    v_fmac_f32 v68, v14, v28
    v_fmac_f32 v69, v14, v29
    v_fmac_f32 v70, v14, v30
    v_fmac_f32 v71, v14, v31
    v_fmac_f32 v72, v14, v32
    v_fmac_f32 v73, v14, v33
    v_fmac_f32 v74, v14, v34
    v_fmac_f32 v75, v14, v35
    v_cvt_pk_bf16_f32 v68, v68, v68
    v_cvt_pk_bf16_f32 v69, v69, v69
    v_cvt_pk_bf16_f32 v70, v70, v70
    v_cvt_pk_bf16_f32 v71, v71, v71
    v_cvt_pk_bf16_f32 v72, v72, v72
    v_cvt_pk_bf16_f32 v73, v73, v73
    v_cvt_pk_bf16_f32 v74, v74, v74
    v_cvt_pk_bf16_f32 v75, v75, v75
    v_and_b32 v40, v68, v36
    v_and_b32 v41, v68, v37
    v_and_b32 v42, v68, v38
    v_and_b32 v43, v68, v39
    v_and_b32 v44, v69, v36
    v_and_b32 v45, v69, v37
    v_and_b32 v46, v69, v38
    v_and_b32 v47, v69, v39
    v_mfma_f32_16x16x32_bf16 v[48:51], v[80:83], v[40:43], v[48:51]
    v_mfma_f32_16x16x32_bf16 v[52:55], v[84:87], v[40:43], v[52:55]
    v_mfma_f32_16x16x32_bf16 v[56:59], v[88:91], v[40:43], v[56:59]
    v_mfma_f32_16x16x32_bf16 v[60:63], v[92:95], v[40:43], v[60:63]
    v_mfma_f32_16x16x32_bf16 v[64:67], v[96:99], v[40:43], v[64:67]
    v_and_b32 v40, v70, v36
    v_and_b32 v41, v70, v37
    v_and_b32 v42, v70, v38
    v_and_b32 v43, v70, v39
    v_mfma_f32_16x16x32_bf16 v[48:51], v[100:103], v[44:47], v[48:51]
    v_mfma_f32_16x16x32_bf16 v[52:55], v[104:107], v[44:47], v[52:55]
    v_mfma_f32_16x16x32_bf16 v[56:59], v[108:111], v[44:47], v[56:59]
    v_mfma_f32_16x16x32_bf16 v[60:63], v[112:115], v[44:47], v[60:63]
    v_mfma_f32_16x16x32_bf16 v[64:67], v[116:119], v[44:47], v[64:67]
    v_and_b32 v44, v71, v36
    v_and_b32 v45, v71, v37
    v_and_b32 v46, v71, v38
    v_and_b32 v47, v71, v39
    v_mfma_f32_16x16x32_bf16 v[48:51], v[120:123], v[40:43], v[48:51]
    v_mfma_f32_16x16x32_bf16 v[52:55], v[124:127], v[40:43], v[52:55]
    v_mfma_f32_16x16x32_bf16 v[56:59], v[128:131], v[40:43], v[56:59]
    v_mfma_f32_16x16x32_bf16 v[60:63], v[132:135], v[40:43], v[60:63]
    v_mfma_f32_16x16x32_bf16 v[64:67], v[136:139], v[40:43], v[64:67]
    v_and_b32 v40, v72, v36
    v_and_b32 v41, v72, v37
    v_and_b32 v42, v72, v38
    v_and_b32 v43, v72, v39
    v_mfma_f32_16x16x32_bf16 v[48:51], v[140:143], v[44:47], v[48:51]
    v_mfma_f32_16x16x32_bf16 v[52:55], v[144:147], v[44:47], v[52:55]
    v_mfma_f32_16x16x32_bf16 v[56:59], v[148:151], v[44:47], v[56:59]
    v_mfma_f32_16x16x32_bf16 v[60:63], v[152:155], v[44:47], v[60:63]
    v_mfma_f32_16x16x32_bf16 v[64:67], v[156:159], v[44:47], v[64:67]
    v_and_b32 v44, v73, v36
    v_and_b32 v45, v73, v37
    v_and_b32 v46, v73, v38
    v_and_b32 v47, v73, v39
    v_mfma_f32_16x16x32_bf16 v[48:51], v[160:163], v[40:43], v[48:51]
    v_mfma_f32_16x16x32_bf16 v[52:55], v[164:167], v[40:43], v[52:55]
    v_mfma_f32_16x16x32_bf16 v[56:59], v[168:171], v[40:43], v[56:59]
    v_mfma_f32_16x16x32_bf16 v[60:63], v[172:175], v[40:43], v[60:63]
    v_mfma_f32_16x16x32_bf16 v[64:67], v[176:179], v[40:43], v[64:67]
    v_and_b32 v40, v74, v36
    v_and_b32 v41, v74, v37
    v_and_b32 v42, v74, v38
    v_and_b32 v43, v74, v39
    v_mfma_f32_16x16x32_bf16 v[48:51], v[180:183], v[44:47], v[48:51]
    v_mfma_f32_16x16x32_bf16 v[52:55], v[184:187], v[44:47], v[52:55]
    v_mfma_f32_16x16x32_bf16 v[56:59], v[188:191], v[44:47], v[56:59]
    v_mfma_f32_16x16x32_bf16 v[60:63], v[192:195], v[44:47], v[60:63]
    v_mfma_f32_16x16x32_bf16 v[64:67], v[196:199], v[44:47], v[64:67]
    v_and_b32 v44, v75, v36
    v_and_b32 v45, v75, v37
    v_and_b32 v46, v75, v38
    v_and_b32 v47, v75, v39
    v_mfma_f32_16x16x32_bf16 v[48:51], v[200:203], v[40:43], v[48:51]
    v_mfma_f32_16x16x32_bf16 v[52:55], v[204:207], v[40:43], v[52:55]
    v_mfma_f32_16x16x32_bf16 v[56:59], v[208:211], v[40:43], v[56:59]
    v_mfma_f32_16x16x32_bf16 v[60:63], v[212:215], v[40:43], v[60:63]
    v_mfma_f32_16x16x32_bf16 v[64:67], v[216:219], v[40:43], v[64:67]
    s_nop 1
    v_mfma_f32_16x16x32_bf16 v[48:51], v[220:223], v[44:47], v[48:51]
    v_mfma_f32_16x16x32_bf16 v[52:55], v[224:227], v[44:47], v[52:55]
    v_mfma_f32_16x16x32_bf16 v[56:59], v[228:231], v[44:47], v[56:59]
    v_mfma_f32_16x16x32_bf16 v[60:63], v[232:235], v[44:47], v[60:63]
    v_mfma_f32_16x16x32_bf16 v[64:67], v[236:239], v[44:47], v[64:67]
    s_nop 3
    s_mov_b32 exec_lo, 0x00ff00ff
    s_mov_b32 exec_hi, 0x00ff00ff
    ds_write_b32 v5, v48 offset:22656
    ds_write_b32 v5, v49 offset:22688
    ds_write_b32 v5, v50 offset:22720
    ds_write_b32 v5, v51 offset:22752
    ds_write_b32 v5, v52 offset:23168
    ds_write_b32 v5, v53 offset:23200
    ds_write_b32 v5, v54 offset:23232
    ds_write_b32 v5, v55 offset:23264
    ds_write_b32 v5, v56 offset:23680
    ds_write_b32 v5, v57 offset:23712
    ds_write_b32 v5, v58 offset:23744
    ds_write_b32 v5, v59 offset:23776
    ds_write_b32 v5, v60 offset:24192
    ds_write_b32 v5, v61 offset:24224
    ds_write_b32 v5, v62 offset:24256
    ds_write_b32 v5, v63 offset:24288
    ds_write_b32 v5, v64 offset:24704
    ds_write_b32 v5, v65 offset:24736
    ds_write_b32 v5, v66 offset:24768
    ds_write_b32 v5, v67 offset:24800
    s_mov_b64 exec, -1
    s_waitcnt lgkmcnt(0)
    v_mov_b32 v5, 22592
    v_mov_b32 v6, 1
    s_mov_b64 exec, 1
    ds_add_u32 v5, v6 offset:16
    s_waitcnt lgkmcnt(0)
    s_mov_b64 exec, -1
    s_branch L_exit
L_stream:
    s_barrier
    buffer_load_dwordx4 v[80:83], v225, s[36:39], s44 offen offset:0 nt
    buffer_load_dwordx4 v[84:87], v225, s[36:39], s44 offen offset:1024 nt
    buffer_load_dwordx4 v[88:91], v225, s[36:39], s44 offen offset:2048 nt
    buffer_load_dwordx4 v[92:95], v225, s[36:39], s44 offen offset:3072 nt
    s_add_u32 s44, s44, 16384
    buffer_load_dwordx4 v[96:99], v226, s[36:39], s44 offen offset:0 nt
    buffer_load_dwordx4 v[100:103], v226, s[36:39], s44 offen offset:1024 nt
    buffer_load_dwordx4 v[104:107], v226, s[36:39], s44 offen offset:2048 nt
    buffer_load_dwordx4 v[108:111], v226, s[36:39], s44 offen offset:3072 nt
    s_add_u32 s44, s44, 16384
    buffer_load_dwordx4 v[112:115], v227, s[36:39], s44 offen offset:0 nt
    buffer_load_dwordx4 v[116:119], v227, s[36:39], s44 offen offset:1024 nt
    buffer_load_dwordx4 v[120:123], v227, s[36:39], s44 offen offset:2048 nt
    buffer_load_dwordx4 v[124:127], v227, s[36:39], s44 offen offset:3072 nt
    s_add_u32 s44, s44, 16384
    v_and_b32 v44, 1, v1
    v_mov_b32 v45, 0xffff
    v_cmp_eq_u32 vcc, 1, v44
    v_mov_b32 v44, 0xffff0000
    s_nop 0
    v_cndmask_b32 v44, v45, v44, vcc
    v_lshrrev_b32 v45, 1, v1
    v_cmp_eq_u32 vcc, 0, v45
    s_nop 1
    v_cndmask_b32 v12, 0, v44, vcc
    v_cmp_eq_u32 vcc, 1, v45
    s_nop 1
    v_cndmask_b32 v13, 0, v44, vcc
    v_cmp_eq_u32 vcc, 2, v45
    s_nop 1
    v_cndmask_b32 v14, 0, v44, vcc
    v_cmp_eq_u32 vcc, 3, v45
    s_nop 1
    v_cndmask_b32 v15, 0, v44, vcc
    v_bfe_u32 v44, v0, 2, 1
    v_bfe_u32 v45, v0, 3, 1
    v_lshl_or_b32 v44, v44, 1, v45
    v_lshlrev_b32 v44, 2, v44
    v_lshl_or_b32 v44, v2, 4, v44
    s_lshl_b32 s46, s32, 12
    v_add_u32 v4, s46, v44
    v_lshlrev_b32 v45, 4, v0
    v_add_u32 v5, s46, v45
    v_lshlrev_b32 v45, 4, v2
    v_add_u32 v6, s46, v45
    v_lshlrev_b32 v7, 5, v1
    s_barrier
    ds_read_b128 v[44:47], v7 offset:16384
    ds_read_b128 v[48:51], v7 offset:16400
    ds_read_b128 v[52:55], v7 offset:16896
    ds_read_b128 v[56:59], v7 offset:16912
    s_waitcnt lgkmcnt(0)
    v_add_f32 v16, v44, v52
    v_add_f32 v17, v45, v53
    v_add_f32 v18, v46, v54
    v_add_f32 v19, v47, v55
    v_add_f32 v20, v48, v56
    v_add_f32 v21, v49, v57
    v_add_f32 v22, v50, v58
    v_add_f32 v23, v51, v59
    ds_read_b128 v[44:47], v7 offset:17408
    ds_read_b128 v[48:51], v7 offset:17424
    ds_read_b128 v[52:55], v7 offset:17920
    ds_read_b128 v[56:59], v7 offset:17936
    s_waitcnt lgkmcnt(0)
    v_add_f32 v44, v44, v52
    v_add_f32 v45, v45, v53
    v_add_f32 v46, v46, v54
    v_add_f32 v47, v47, v55
    v_add_f32 v48, v48, v56
    v_add_f32 v49, v49, v57
    v_add_f32 v50, v50, v58
    v_add_f32 v51, v51, v59
    v_add_f32 v44, v44, v16
    v_add_f32 v45, v45, v17
    v_add_f32 v46, v46, v18
    v_add_f32 v47, v47, v19
    v_add_f32 v48, v48, v20
    v_add_f32 v49, v49, v21
    v_add_f32 v50, v50, v22
    v_add_f32 v51, v51, v23
    v_cvt_pk_bf16_f32 v8, v44, v45
    v_cvt_pk_bf16_f32 v9, v46, v47
    v_cvt_pk_bf16_f32 v10, v48, v49
    v_cvt_pk_bf16_f32 v11, v50, v51
    s_nop 1
    s_waitcnt vmcnt(12)
    v_dot2_f32_bf16 v16, v64, v8, 0
    v_dot2_f32_bf16 v17, v68, v8, 0
    v_dot2_f32_bf16 v18, v72, v8, 0
    v_dot2_f32_bf16 v19, v76, v8, 0
    v_dot2_f32_bf16 v16, v65, v9, v16
    v_dot2_f32_bf16 v17, v69, v9, v17
    v_dot2_f32_bf16 v18, v73, v9, v18
    v_dot2_f32_bf16 v19, v77, v9, v19
    v_dot2_f32_bf16 v16, v66, v10, v16
    v_dot2_f32_bf16 v17, v70, v10, v17
    v_dot2_f32_bf16 v18, v74, v10, v18
    v_dot2_f32_bf16 v19, v78, v10, v19
    v_dot2_f32_bf16 v16, v67, v11, v16
    v_dot2_f32_bf16 v17, v71, v11, v17
    v_dot2_f32_bf16 v18, v75, v11, v18
    v_dot2_f32_bf16 v19, v79, v11, v19
    s_nop 3
    v_add_f32_dpp v20, v16, v16 row_ror:8 row_mask:0xf bank_mask:0x3
    v_add_f32_dpp v20, v17, v17 row_ror:8 row_mask:0xf bank_mask:0xc
    v_add_f32_dpp v21, v18, v18 row_ror:8 row_mask:0xf bank_mask:0x3
    v_add_f32_dpp v21, v19, v19 row_ror:8 row_mask:0xf bank_mask:0xc
    s_nop 0
    v_add_f32_dpp v22, v20, v20 row_half_mirror row_mask:0xf bank_mask:0x5
    v_add_f32_dpp v22, v21, v21 row_half_mirror row_mask:0xf bank_mask:0xa
    s_nop 1
    v_add_f32_dpp v23, v22, v22 quad_perm:[1,0,3,2] row_mask:0xf bank_mask:0xf
    s_nop 1
    v_add_f32_dpp v22, v23, v23 quad_perm:[2,3,0,1] row_mask:0xf bank_mask:0xf
    ds_write_b32 v4, v22 offset:0
    s_waitcnt vmcnt(8)
    v_dot2_f32_bf16 v16, v80, v8, 0
    v_dot2_f32_bf16 v17, v84, v8, 0
    v_dot2_f32_bf16 v18, v88, v8, 0
    v_dot2_f32_bf16 v19, v92, v8, 0
    v_dot2_f32_bf16 v16, v81, v9, v16
    v_dot2_f32_bf16 v17, v85, v9, v17
    v_dot2_f32_bf16 v18, v89, v9, v18
    v_dot2_f32_bf16 v19, v93, v9, v19
    v_dot2_f32_bf16 v16, v82, v10, v16
    v_dot2_f32_bf16 v17, v86, v10, v17
    v_dot2_f32_bf16 v18, v90, v10, v18
    v_dot2_f32_bf16 v19, v94, v10, v19
    v_dot2_f32_bf16 v16, v83, v11, v16
    v_dot2_f32_bf16 v17, v87, v11, v17
    v_dot2_f32_bf16 v18, v91, v11, v18
    v_dot2_f32_bf16 v19, v95, v11, v19
    s_nop 3
    v_add_f32_dpp v20, v16, v16 row_ror:8 row_mask:0xf bank_mask:0x3
    v_add_f32_dpp v20, v17, v17 row_ror:8 row_mask:0xf bank_mask:0xc
    v_add_f32_dpp v21, v18, v18 row_ror:8 row_mask:0xf bank_mask:0x3
    v_add_f32_dpp v21, v19, v19 row_ror:8 row_mask:0xf bank_mask:0xc
    s_nop 0
    v_add_f32_dpp v22, v20, v20 row_half_mirror row_mask:0xf bank_mask:0x5
    v_add_f32_dpp v22, v21, v21 row_half_mirror row_mask:0xf bank_mask:0xa
    s_nop 1
    v_add_f32_dpp v23, v22, v22 quad_perm:[1,0,3,2] row_mask:0xf bank_mask:0xf
    s_nop 1
    v_add_f32_dpp v22, v23, v23 quad_perm:[2,3,0,1] row_mask:0xf bank_mask:0xf
    ds_write_b32 v4, v22 offset:64
    s_waitcnt vmcnt(4)
    v_dot2_f32_bf16 v16, v96, v8, 0
    v_dot2_f32_bf16 v17, v100, v8, 0
    v_dot2_f32_bf16 v18, v104, v8, 0
    v_dot2_f32_bf16 v19, v108, v8, 0
    v_dot2_f32_bf16 v16, v97, v9, v16
    v_dot2_f32_bf16 v17, v101, v9, v17
    v_dot2_f32_bf16 v18, v105, v9, v18
    v_dot2_f32_bf16 v19, v109, v9, v19
    v_dot2_f32_bf16 v16, v98, v10, v16
    v_dot2_f32_bf16 v17, v102, v10, v17
    v_dot2_f32_bf16 v18, v106, v10, v18
    v_dot2_f32_bf16 v19, v110, v10, v19
    v_dot2_f32_bf16 v16, v99, v11, v16
    v_dot2_f32_bf16 v17, v103, v11, v17
    v_dot2_f32_bf16 v18, v107, v11, v18
    v_dot2_f32_bf16 v19, v111, v11, v19
    s_nop 3
    v_add_f32_dpp v20, v16, v16 row_ror:8 row_mask:0xf bank_mask:0x3
    v_add_f32_dpp v20, v17, v17 row_ror:8 row_mask:0xf bank_mask:0xc
    v_add_f32_dpp v21, v18, v18 row_ror:8 row_mask:0xf bank_mask:0x3
    v_add_f32_dpp v21, v19, v19 row_ror:8 row_mask:0xf bank_mask:0xc
    s_nop 0
    v_add_f32_dpp v22, v20, v20 row_half_mirror row_mask:0xf bank_mask:0x5
    v_add_f32_dpp v22, v21, v21 row_half_mirror row_mask:0xf bank_mask:0xa
    s_nop 1
    v_add_f32_dpp v23, v22, v22 quad_perm:[1,0,3,2] row_mask:0xf bank_mask:0xf
    s_nop 1
    v_add_f32_dpp v22, v23, v23 quad_perm:[2,3,0,1] row_mask:0xf bank_mask:0xf
    ds_write_b32 v4, v22 offset:128
    s_waitcnt vmcnt(0)
    buffer_load_dwordx4 v[64:67], v224, s[36:39], s44 offen offset:0 nt
    buffer_load_dwordx4 v[68:71], v224, s[36:39], s44 offen offset:1024 nt
    buffer_load_dwordx4 v[72:75], v224, s[36:39], s44 offen offset:2048 nt
    buffer_load_dwordx4 v[76:79], v224, s[36:39], s44 offen offset:3072 nt
    s_add_u32 s44, s44, 16384
    v_dot2_f32_bf16 v16, v112, v8, 0
    v_dot2_f32_bf16 v17, v116, v8, 0
    v_dot2_f32_bf16 v18, v120, v8, 0
    v_dot2_f32_bf16 v19, v124, v8, 0
    v_dot2_f32_bf16 v16, v113, v9, v16
    v_dot2_f32_bf16 v17, v117, v9, v17
    v_dot2_f32_bf16 v18, v121, v9, v18
    v_dot2_f32_bf16 v19, v125, v9, v19
    v_dot2_f32_bf16 v16, v114, v10, v16
    v_dot2_f32_bf16 v17, v118, v10, v17
    v_dot2_f32_bf16 v18, v122, v10, v18
    v_dot2_f32_bf16 v19, v126, v10, v19
    v_dot2_f32_bf16 v16, v115, v11, v16
    v_dot2_f32_bf16 v17, v119, v11, v17
    v_dot2_f32_bf16 v18, v123, v11, v18
    v_dot2_f32_bf16 v19, v127, v11, v19
    s_nop 3
    v_add_f32_dpp v20, v16, v16 row_ror:8 row_mask:0xf bank_mask:0x3
    v_add_f32_dpp v20, v17, v17 row_ror:8 row_mask:0xf bank_mask:0xc
    v_add_f32_dpp v21, v18, v18 row_ror:8 row_mask:0xf bank_mask:0x3
    v_add_f32_dpp v21, v19, v19 row_ror:8 row_mask:0xf bank_mask:0xc
    s_nop 0
    v_add_f32_dpp v22, v20, v20 row_half_mirror row_mask:0xf bank_mask:0x5
    v_add_f32_dpp v22, v21, v21 row_half_mirror row_mask:0xf bank_mask:0xa
    s_nop 1
    v_add_f32_dpp v23, v22, v22 quad_perm:[1,0,3,2] row_mask:0xf bank_mask:0xf
    s_nop 1
    v_add_f32_dpp v22, v23, v23 quad_perm:[2,3,0,1] row_mask:0xf bank_mask:0xf
    ds_write_b32 v4, v22 offset:192
    s_mov_b32 s47, 14
    v_add_u32 v4, 256, v4
L_kloop:
    s_waitcnt vmcnt(0)
    buffer_load_dwordx4 v[80:83], v225, s[36:39], s44 offen offset:0 nt
    buffer_load_dwordx4 v[84:87], v225, s[36:39], s44 offen offset:1024 nt
    buffer_load_dwordx4 v[88:91], v225, s[36:39], s44 offen offset:2048 nt
    buffer_load_dwordx4 v[92:95], v225, s[36:39], s44 offen offset:3072 nt
    s_add_u32 s44, s44, 16384
    buffer_load_dwordx4 v[96:99], v226, s[36:39], s44 offen offset:0 nt
    buffer_load_dwordx4 v[100:103], v226, s[36:39], s44 offen offset:1024 nt
    buffer_load_dwordx4 v[104:107], v226, s[36:39], s44 offen offset:2048 nt
    buffer_load_dwordx4 v[108:111], v226, s[36:39], s44 offen offset:3072 nt
    s_add_u32 s44, s44, 16384
    v_dot2_f32_bf16 v16, v64, v8, 0
    v_dot2_f32_bf16 v17, v68, v8, 0
    v_dot2_f32_bf16 v18, v72, v8, 0
    v_dot2_f32_bf16 v19, v76, v8, 0
    v_dot2_f32_bf16 v16, v65, v9, v16
    v_dot2_f32_bf16 v17, v69, v9, v17
    v_dot2_f32_bf16 v18, v73, v9, v18
    v_dot2_f32_bf16 v19, v77, v9, v19
    v_dot2_f32_bf16 v16, v66, v10, v16
    v_dot2_f32_bf16 v17, v70, v10, v17
    v_dot2_f32_bf16 v18, v74, v10, v18
    v_dot2_f32_bf16 v19, v78, v10, v19
    v_dot2_f32_bf16 v16, v67, v11, v16
    v_dot2_f32_bf16 v17, v71, v11, v17
    v_dot2_f32_bf16 v18, v75, v11, v18
    v_dot2_f32_bf16 v19, v79, v11, v19
    s_nop 3
    v_add_f32_dpp v20, v16, v16 row_ror:8 row_mask:0xf bank_mask:0x3
    v_add_f32_dpp v20, v17, v17 row_ror:8 row_mask:0xf bank_mask:0xc
    v_add_f32_dpp v21, v18, v18 row_ror:8 row_mask:0xf bank_mask:0x3
    v_add_f32_dpp v21, v19, v19 row_ror:8 row_mask:0xf bank_mask:0xc
    s_nop 0
    v_add_f32_dpp v22, v20, v20 row_half_mirror row_mask:0xf bank_mask:0x5
    v_add_f32_dpp v22, v21, v21 row_half_mirror row_mask:0xf bank_mask:0xa
    s_nop 1
    v_add_f32_dpp v23, v22, v22 quad_perm:[1,0,3,2] row_mask:0xf bank_mask:0xf
    s_nop 1
    v_add_f32_dpp v22, v23, v23 quad_perm:[2,3,0,1] row_mask:0xf bank_mask:0xf
    ds_write_b32 v4, v22 offset:0
    s_waitcnt vmcnt(4)
    buffer_load_dwordx4 v[112:115], v227, s[36:39], s44 offen offset:0 nt
    buffer_load_dwordx4 v[116:119], v227, s[36:39], s44 offen offset:1024 nt
    buffer_load_dwordx4 v[120:123], v227, s[36:39], s44 offen offset:2048 nt
    buffer_load_dwordx4 v[124:127], v227, s[36:39], s44 offen offset:3072 nt
    s_add_u32 s44, s44, 16384
    v_dot2_f32_bf16 v16, v80, v8, 0
    v_dot2_f32_bf16 v17, v84, v8, 0
    v_dot2_f32_bf16 v18, v88, v8, 0
    v_dot2_f32_bf16 v19, v92, v8, 0
    v_dot2_f32_bf16 v16, v81, v9, v16
    v_dot2_f32_bf16 v17, v85, v9, v17
    v_dot2_f32_bf16 v18, v89, v9, v18
    v_dot2_f32_bf16 v19, v93, v9, v19
    v_dot2_f32_bf16 v16, v82, v10, v16
    v_dot2_f32_bf16 v17, v86, v10, v17
    v_dot2_f32_bf16 v18, v90, v10, v18
    v_dot2_f32_bf16 v19, v94, v10, v19
    v_dot2_f32_bf16 v16, v83, v11, v16
    v_dot2_f32_bf16 v17, v87, v11, v17
    v_dot2_f32_bf16 v18, v91, v11, v18
    v_dot2_f32_bf16 v19, v95, v11, v19
    s_nop 3
    v_add_f32_dpp v20, v16, v16 row_ror:8 row_mask:0xf bank_mask:0x3
    v_add_f32_dpp v20, v17, v17 row_ror:8 row_mask:0xf bank_mask:0xc
    v_add_f32_dpp v21, v18, v18 row_ror:8 row_mask:0xf bank_mask:0x3
    v_add_f32_dpp v21, v19, v19 row_ror:8 row_mask:0xf bank_mask:0xc
    s_nop 0
    v_add_f32_dpp v22, v20, v20 row_half_mirror row_mask:0xf bank_mask:0x5
    v_add_f32_dpp v22, v21, v21 row_half_mirror row_mask:0xf bank_mask:0xa
    s_nop 1
    v_add_f32_dpp v23, v22, v22 quad_perm:[1,0,3,2] row_mask:0xf bank_mask:0xf
    s_nop 1
    v_add_f32_dpp v22, v23, v23 quad_perm:[2,3,0,1] row_mask:0xf bank_mask:0xf
    ds_write_b32 v4, v22 offset:64
    s_waitcnt vmcnt(4)
    v_dot2_f32_bf16 v16, v96, v8, 0
    v_dot2_f32_bf16 v17, v100, v8, 0
    v_dot2_f32_bf16 v18, v104, v8, 0
    v_dot2_f32_bf16 v19, v108, v8, 0
    v_dot2_f32_bf16 v16, v97, v9, v16
    v_dot2_f32_bf16 v17, v101, v9, v17
    v_dot2_f32_bf16 v18, v105, v9, v18
    v_dot2_f32_bf16 v19, v109, v9, v19
    v_dot2_f32_bf16 v16, v98, v10, v16
    v_dot2_f32_bf16 v17, v102, v10, v17
    v_dot2_f32_bf16 v18, v106, v10, v18
    v_dot2_f32_bf16 v19, v110, v10, v19
    v_dot2_f32_bf16 v16, v99, v11, v16
    v_dot2_f32_bf16 v17, v103, v11, v17
    v_dot2_f32_bf16 v18, v107, v11, v18
    v_dot2_f32_bf16 v19, v111, v11, v19
    s_nop 3
    v_add_f32_dpp v20, v16, v16 row_ror:8 row_mask:0xf bank_mask:0x3
    v_add_f32_dpp v20, v17, v17 row_ror:8 row_mask:0xf bank_mask:0xc
    v_add_f32_dpp v21, v18, v18 row_ror:8 row_mask:0xf bank_mask:0x3
    v_add_f32_dpp v21, v19, v19 row_ror:8 row_mask:0xf bank_mask:0xc
    s_nop 0
    v_add_f32_dpp v22, v20, v20 row_half_mirror row_mask:0xf bank_mask:0x5
    v_add_f32_dpp v22, v21, v21 row_half_mirror row_mask:0xf bank_mask:0xa
    s_nop 1
    v_add_f32_dpp v23, v22, v22 quad_perm:[1,0,3,2] row_mask:0xf bank_mask:0xf
    s_nop 1
    v_add_f32_dpp v22, v23, v23 quad_perm:[2,3,0,1] row_mask:0xf bank_mask:0xf
    ds_write_b32 v4, v22 offset:128
    s_waitcnt vmcnt(0)
    buffer_load_dwordx4 v[64:67], v224, s[36:39], s44 offen offset:0 nt
    buffer_load_dwordx4 v[68:71], v224, s[36:39], s44 offen offset:1024 nt
    buffer_load_dwordx4 v[72:75], v224, s[36:39], s44 offen offset:2048 nt
    buffer_load_dwordx4 v[76:79], v224, s[36:39], s44 offen offset:3072 nt
    s_add_u32 s44, s44, 16384
    v_dot2_f32_bf16 v16, v112, v8, 0
    v_dot2_f32_bf16 v17, v116, v8, 0
    v_dot2_f32_bf16 v18, v120, v8, 0
    v_dot2_f32_bf16 v19, v124, v8, 0
    v_dot2_f32_bf16 v16, v113, v9, v16
    v_dot2_f32_bf16 v17, v117, v9, v17
    v_dot2_f32_bf16 v18, v121, v9, v18
    v_dot2_f32_bf16 v19, v125, v9, v19
    v_dot2_f32_bf16 v16, v114, v10, v16
    v_dot2_f32_bf16 v17, v118, v10, v17
    v_dot2_f32_bf16 v18, v122, v10, v18
    v_dot2_f32_bf16 v19, v126, v10, v19
    v_dot2_f32_bf16 v16, v115, v11, v16
    v_dot2_f32_bf16 v17, v119, v11, v17
    v_dot2_f32_bf16 v18, v123, v11, v18
    v_dot2_f32_bf16 v19, v127, v11, v19
    s_nop 3
    v_add_f32_dpp v20, v16, v16 row_ror:8 row_mask:0xf bank_mask:0x3
    v_add_f32_dpp v20, v17, v17 row_ror:8 row_mask:0xf bank_mask:0xc
    v_add_f32_dpp v21, v18, v18 row_ror:8 row_mask:0xf bank_mask:0x3
    v_add_f32_dpp v21, v19, v19 row_ror:8 row_mask:0xf bank_mask:0xc
    s_nop 0
    v_add_f32_dpp v22, v20, v20 row_half_mirror row_mask:0xf bank_mask:0x5
    v_add_f32_dpp v22, v21, v21 row_half_mirror row_mask:0xf bank_mask:0xa
    s_nop 1
    v_add_f32_dpp v23, v22, v22 quad_perm:[1,0,3,2] row_mask:0xf bank_mask:0xf
    s_nop 1
    v_add_f32_dpp v22, v23, v23 quad_perm:[2,3,0,1] row_mask:0xf bank_mask:0xf
    ds_write_b32 v4, v22 offset:192
    v_add_u32 v4, 256, v4
    s_sub_u32 s47, s47, 1
    s_cmp_lg_u32 s47, 0
    s_cbranch_scc1 L_kloop
    s_waitcnt vmcnt(0)
    buffer_load_dwordx4 v[80:83], v225, s[36:39], s44 offen offset:0 nt
    buffer_load_dwordx4 v[84:87], v225, s[36:39], s44 offen offset:1024 nt
    buffer_load_dwordx4 v[88:91], v225, s[36:39], s44 offen offset:2048 nt
    buffer_load_dwordx4 v[92:95], v225, s[36:39], s44 offen offset:3072 nt
    s_add_u32 s44, s44, 16384
    buffer_load_dwordx4 v[96:99], v226, s[36:39], s44 offen offset:0 nt
    buffer_load_dwordx4 v[100:103], v226, s[36:39], s44 offen offset:1024 nt
    buffer_load_dwordx4 v[104:107], v226, s[36:39], s44 offen offset:2048 nt
    buffer_load_dwordx4 v[108:111], v226, s[36:39], s44 offen offset:3072 nt
    s_add_u32 s44, s44, 16384
    v_dot2_f32_bf16 v16, v64, v8, 0
    v_dot2_f32_bf16 v17, v68, v8, 0
    v_dot2_f32_bf16 v18, v72, v8, 0
    v_dot2_f32_bf16 v19, v76, v8, 0
    v_dot2_f32_bf16 v16, v65, v9, v16
    v_dot2_f32_bf16 v17, v69, v9, v17
    v_dot2_f32_bf16 v18, v73, v9, v18
    v_dot2_f32_bf16 v19, v77, v9, v19
    v_dot2_f32_bf16 v16, v66, v10, v16
    v_dot2_f32_bf16 v17, v70, v10, v17
    v_dot2_f32_bf16 v18, v74, v10, v18
    v_dot2_f32_bf16 v19, v78, v10, v19
    v_dot2_f32_bf16 v16, v67, v11, v16
    v_dot2_f32_bf16 v17, v71, v11, v17
    v_dot2_f32_bf16 v18, v75, v11, v18
    v_dot2_f32_bf16 v19, v79, v11, v19
    s_nop 3
    v_add_f32_dpp v20, v16, v16 row_ror:8 row_mask:0xf bank_mask:0x3
    v_add_f32_dpp v20, v17, v17 row_ror:8 row_mask:0xf bank_mask:0xc
    v_add_f32_dpp v21, v18, v18 row_ror:8 row_mask:0xf bank_mask:0x3
    v_add_f32_dpp v21, v19, v19 row_ror:8 row_mask:0xf bank_mask:0xc
    s_nop 0
    v_add_f32_dpp v22, v20, v20 row_half_mirror row_mask:0xf bank_mask:0x5
    v_add_f32_dpp v22, v21, v21 row_half_mirror row_mask:0xf bank_mask:0xa
    s_nop 1
    v_add_f32_dpp v23, v22, v22 quad_perm:[1,0,3,2] row_mask:0xf bank_mask:0xf
    s_nop 1
    v_add_f32_dpp v22, v23, v23 quad_perm:[2,3,0,1] row_mask:0xf bank_mask:0xf
    ds_write_b32 v4, v22 offset:0
    s_waitcnt vmcnt(4)
    buffer_load_dwordx4 v[112:115], v227, s[36:39], s44 offen offset:0 nt
    buffer_load_dwordx4 v[116:119], v227, s[36:39], s44 offen offset:1024 nt
    buffer_load_dwordx4 v[120:123], v227, s[36:39], s44 offen offset:2048 nt
    buffer_load_dwordx4 v[124:127], v227, s[36:39], s44 offen offset:3072 nt
    s_add_u32 s44, s44, 16384
    v_dot2_f32_bf16 v16, v80, v8, 0
    v_dot2_f32_bf16 v17, v84, v8, 0
    v_dot2_f32_bf16 v18, v88, v8, 0
    v_dot2_f32_bf16 v19, v92, v8, 0
    v_dot2_f32_bf16 v16, v81, v9, v16
    v_dot2_f32_bf16 v17, v85, v9, v17
    v_dot2_f32_bf16 v18, v89, v9, v18
    v_dot2_f32_bf16 v19, v93, v9, v19
    v_dot2_f32_bf16 v16, v82, v10, v16
    v_dot2_f32_bf16 v17, v86, v10, v17
    v_dot2_f32_bf16 v18, v90, v10, v18
    v_dot2_f32_bf16 v19, v94, v10, v19
    v_dot2_f32_bf16 v16, v83, v11, v16
    v_dot2_f32_bf16 v17, v87, v11, v17
    v_dot2_f32_bf16 v18, v91, v11, v18
    v_dot2_f32_bf16 v19, v95, v11, v19
    s_nop 3
    v_add_f32_dpp v20, v16, v16 row_ror:8 row_mask:0xf bank_mask:0x3
    v_add_f32_dpp v20, v17, v17 row_ror:8 row_mask:0xf bank_mask:0xc
    v_add_f32_dpp v21, v18, v18 row_ror:8 row_mask:0xf bank_mask:0x3
    v_add_f32_dpp v21, v19, v19 row_ror:8 row_mask:0xf bank_mask:0xc
    s_nop 0
    v_add_f32_dpp v22, v20, v20 row_half_mirror row_mask:0xf bank_mask:0x5
    v_add_f32_dpp v22, v21, v21 row_half_mirror row_mask:0xf bank_mask:0xa
    s_nop 1
    v_add_f32_dpp v23, v22, v22 quad_perm:[1,0,3,2] row_mask:0xf bank_mask:0xf
    s_nop 1
    v_add_f32_dpp v22, v23, v23 quad_perm:[2,3,0,1] row_mask:0xf bank_mask:0xf
    ds_write_b32 v4, v22 offset:64
    s_waitcnt vmcnt(4)
    v_dot2_f32_bf16 v16, v96, v8, 0
    v_dot2_f32_bf16 v17, v100, v8, 0
    v_dot2_f32_bf16 v18, v104, v8, 0
    v_dot2_f32_bf16 v19, v108, v8, 0
    v_dot2_f32_bf16 v16, v97, v9, v16
    v_dot2_f32_bf16 v17, v101, v9, v17
    v_dot2_f32_bf16 v18, v105, v9, v18
    v_dot2_f32_bf16 v19, v109, v9, v19
    v_dot2_f32_bf16 v16, v98, v10, v16
    v_dot2_f32_bf16 v17, v102, v10, v17
    v_dot2_f32_bf16 v18, v106, v10, v18
    v_dot2_f32_bf16 v19, v110, v10, v19
    v_dot2_f32_bf16 v16, v99, v11, v16
    v_dot2_f32_bf16 v17, v103, v11, v17
    v_dot2_f32_bf16 v18, v107, v11, v18
    v_dot2_f32_bf16 v19, v111, v11, v19
    s_nop 3
    v_add_f32_dpp v20, v16, v16 row_ror:8 row_mask:0xf bank_mask:0x3
    v_add_f32_dpp v20, v17, v17 row_ror:8 row_mask:0xf bank_mask:0xc
    v_add_f32_dpp v21, v18, v18 row_ror:8 row_mask:0xf bank_mask:0x3
    v_add_f32_dpp v21, v19, v19 row_ror:8 row_mask:0xf bank_mask:0xc
    s_nop 0
    v_add_f32_dpp v22, v20, v20 row_half_mirror row_mask:0xf bank_mask:0x5
    v_add_f32_dpp v22, v21, v21 row_half_mirror row_mask:0xf bank_mask:0xa
    s_nop 1
    v_add_f32_dpp v23, v22, v22 quad_perm:[1,0,3,2] row_mask:0xf bank_mask:0xf
    s_nop 1
    v_add_f32_dpp v22, v23, v23 quad_perm:[2,3,0,1] row_mask:0xf bank_mask:0xf
    ds_write_b32 v4, v22 offset:128
    s_waitcnt vmcnt(0)
    buffer_load_dwordx4 v[64:67], v224, s[40:43], s45 offen offset:0 nt
    buffer_load_dwordx4 v[68:71], v224, s[40:43], s45 offen offset:1024 nt
    buffer_load_dwordx4 v[72:75], v224, s[40:43], s45 offen offset:2048 nt
    buffer_load_dwordx4 v[76:79], v224, s[40:43], s45 offen offset:3072 nt
    s_add_u32 s45, s45, 16384
    v_dot2_f32_bf16 v16, v112, v8, 0
    v_dot2_f32_bf16 v17, v116, v8, 0
    v_dot2_f32_bf16 v18, v120, v8, 0
    v_dot2_f32_bf16 v19, v124, v8, 0
    v_dot2_f32_bf16 v16, v113, v9, v16
    v_dot2_f32_bf16 v17, v117, v9, v17
    v_dot2_f32_bf16 v18, v121, v9, v18
    v_dot2_f32_bf16 v19, v125, v9, v19
    v_dot2_f32_bf16 v16, v114, v10, v16
    v_dot2_f32_bf16 v17, v118, v10, v17
    v_dot2_f32_bf16 v18, v122, v10, v18
    v_dot2_f32_bf16 v19, v126, v10, v19
    v_dot2_f32_bf16 v16, v115, v11, v16
    v_dot2_f32_bf16 v17, v119, v11, v17
    v_dot2_f32_bf16 v18, v123, v11, v18
    v_dot2_f32_bf16 v19, v127, v11, v19
    s_nop 3
    v_add_f32_dpp v20, v16, v16 row_ror:8 row_mask:0xf bank_mask:0x3
    v_add_f32_dpp v20, v17, v17 row_ror:8 row_mask:0xf bank_mask:0xc
    v_add_f32_dpp v21, v18, v18 row_ror:8 row_mask:0xf bank_mask:0x3
    v_add_f32_dpp v21, v19, v19 row_ror:8 row_mask:0xf bank_mask:0xc
    s_nop 0
    v_add_f32_dpp v22, v20, v20 row_half_mirror row_mask:0xf bank_mask:0x5
    v_add_f32_dpp v22, v21, v21 row_half_mirror row_mask:0xf bank_mask:0xa
    s_nop 1
    v_add_f32_dpp v23, v22, v22 quad_perm:[1,0,3,2] row_mask:0xf bank_mask:0xf
    s_nop 1
    v_add_f32_dpp v22, v23, v23 quad_perm:[2,3,0,1] row_mask:0xf bank_mask:0xf
    ds_write_b32 v4, v22 offset:192
    ds_read_b128 v[44:47], v5 offset:0
    ds_read_b128 v[48:51], v5 offset:1024
    ds_read_b128 v[52:55], v5 offset:2048
    ds_read_b128 v[56:59], v5 offset:3072
    s_waitcnt lgkmcnt(0)
    v_max3_f32 v60, v44, v45, v46
    v_max3_f32 v60, v60, v47, v48
    v_max3_f32 v60, v60, v49, v50
    v_max3_f32 v60, v60, v51, v52
    v_max3_f32 v60, v60, v53, v54
    v_max3_f32 v60, v60, v55, v56
    v_max3_f32 v60, v60, v57, v58
    v_max_f32 v60, v60, v59
    s_nop 1
    v_max_f32_dpp v60, v60, v60 row_ror:8 row_mask:0xf bank_mask:0xf
    s_nop 1
    v_max_f32_dpp v60, v60, v60 row_ror:4 row_mask:0xf bank_mask:0xf
    s_nop 1
    v_max_f32_dpp v60, v60, v60 row_ror:2 row_mask:0xf bank_mask:0xf
    s_nop 1
    v_max_f32_dpp v60, v60, v60 row_ror:1 row_mask:0xf bank_mask:0xf
    v_mov_b32 v62, v60
    s_nop 1
    v_permlane16_swap_b32 v62, v60
    s_nop 1
    v_max_f32 v60, v60, v62
    v_mov_b32 v62, v60
    s_nop 1
    v_permlane32_swap_b32 v62, v60
    s_nop 1
    v_max_f32 v60, v60, v62
    s_mov_b32 s46, 0x3e0293ee
    v_mul_f32 v62, s46, v60
    v_fma_f32 v44, v44, s46, -v62
    v_fma_f32 v45, v45, s46, -v62
    v_fma_f32 v46, v46, s46, -v62
    v_fma_f32 v47, v47, s46, -v62
    v_fma_f32 v48, v48, s46, -v62
    v_fma_f32 v49, v49, s46, -v62
    v_fma_f32 v50, v50, s46, -v62
    v_fma_f32 v51, v51, s46, -v62
    v_fma_f32 v52, v52, s46, -v62
    v_fma_f32 v53, v53, s46, -v62
    v_fma_f32 v54, v54, s46, -v62
    v_fma_f32 v55, v55, s46, -v62
    v_fma_f32 v56, v56, s46, -v62
    v_fma_f32 v57, v57, s46, -v62
    v_fma_f32 v58, v58, s46, -v62
    v_fma_f32 v59, v59, s46, -v62
    v_exp_f32 v44, v44
    v_exp_f32 v45, v45
    v_exp_f32 v46, v46
    v_exp_f32 v47, v47
    v_exp_f32 v48, v48
    v_exp_f32 v49, v49
    v_exp_f32 v50, v50
    v_exp_f32 v51, v51
    v_exp_f32 v52, v52
    v_exp_f32 v53, v53
    v_exp_f32 v54, v54
    v_exp_f32 v55, v55
    v_exp_f32 v56, v56
    v_exp_f32 v57, v57
    v_exp_f32 v58, v58
    v_exp_f32 v59, v59
    s_nop 0
    v_add_f32 v61, v44, v45
    v_add_f32 v61, v61, v46
    v_add_f32 v61, v61, v47
    v_add_f32 v61, v61, v48
    v_add_f32 v61, v61, v49
    v_add_f32 v61, v61, v50
    v_add_f32 v61, v61, v51
    v_add_f32 v61, v61, v52
    v_add_f32 v61, v61, v53
    v_add_f32 v61, v61, v54
    v_add_f32 v61, v61, v55
    v_add_f32 v61, v61, v56
    v_add_f32 v61, v61, v57
    v_add_f32 v61, v61, v58
    v_add_f32 v61, v61, v59
    v_cvt_pk_bf16_f32 v44, v44, v44
    v_cvt_pk_bf16_f32 v45, v45, v45
    v_cvt_pk_bf16_f32 v46, v46, v46
    v_cvt_pk_bf16_f32 v47, v47, v47
    v_cvt_pk_bf16_f32 v48, v48, v48
    v_cvt_pk_bf16_f32 v49, v49, v49
    v_cvt_pk_bf16_f32 v50, v50, v50
    v_cvt_pk_bf16_f32 v51, v51, v51
    v_cvt_pk_bf16_f32 v52, v52, v52
    v_cvt_pk_bf16_f32 v53, v53, v53
    v_cvt_pk_bf16_f32 v54, v54, v54
    v_cvt_pk_bf16_f32 v55, v55, v55
    v_cvt_pk_bf16_f32 v56, v56, v56
    v_cvt_pk_bf16_f32 v57, v57, v57
    v_cvt_pk_bf16_f32 v58, v58, v58
    v_cvt_pk_bf16_f32 v59, v59, v59
    ds_write_b128 v5, v[44:47] offset:0
    ds_write_b128 v5, v[48:51] offset:1024
    ds_write_b128 v5, v[52:55] offset:2048
    ds_write_b128 v5, v[56:59] offset:3072
    ds_read_b128 v[28:31], v6 offset:0
    s_nop 1
    v_add_f32_dpp v61, v61, v61 row_ror:8 row_mask:0xf bank_mask:0xf
    s_nop 1
    v_add_f32_dpp v61, v61, v61 row_ror:4 row_mask:0xf bank_mask:0xf
    s_nop 1
    v_add_f32_dpp v61, v61, v61 row_ror:2 row_mask:0xf bank_mask:0xf
    s_nop 1
    v_add_f32_dpp v61, v61, v61 row_ror:1 row_mask:0xf bank_mask:0xf
    v_mov_b32 v62, v61
    s_nop 1
    v_permlane16_swap_b32 v62, v61
    s_nop 1
    v_add_f32 v61, v61, v62
    v_mov_b32 v62, v61
    s_nop 1
    v_permlane32_swap_b32 v62, v61
    s_nop 1
    v_add_f32 v61, v61, v62
    s_lshl_b32 s46, s32, 3
    v_mov_b32 v62, s46
    v_mov_b32 v228, 22592
    v_mov_b32 v229, 1
    s_mov_b64 exec, 1
    ds_write_b64 v62, v[60:61] offset:22528
    ds_add_u32 v228, v229 offset:4
    s_mov_b64 exec, -1
    ds_read_b32 v229, v228 offset:8
    v_mov_b32 v24, 0
    v_mov_b32 v25, 0
    v_mov_b32 v26, 0
    v_mov_b32 v27, 0
    s_mov_b32 s47, 0
L_vit:
    s_waitcnt lgkmcnt(0)
    v_readfirstlane_b32 s52, v229
    s_nop 3
    s_lshr_b32 s53, s52, 8
    s_and_b32 s54, s52, 15
    s_bfe_u32 s55, s52, 0x40004
    s_cmp_ge_u32 s47, s53
    s_cselect_b32 s54, s55, s54
    s_cmp_eq_u32 s54, 1
    s_cbranch_scc1 L_vbody1
    s_cmp_eq_u32 s54, 2
    s_cbranch_scc1 L_vbody2
    s_cmp_eq_u32 s54, 3
    s_cbranch_scc1 L_vbody3
    s_cmp_eq_u32 s54, 4
    s_cbranch_scc1 L_vbody4
L_vbody0:
    s_waitcnt vmcnt(0) lgkmcnt(0)
    buffer_load_dwordx4 v[80:83], v225, s[40:43], s45 offen offset:0 nt
    buffer_load_dwordx4 v[84:87], v225, s[40:43], s45 offen offset:1024 nt
    buffer_load_dwordx4 v[88:91], v225, s[40:43], s45 offen offset:2048 nt
    buffer_load_dwordx4 v[92:95], v225, s[40:43], s45 offen offset:3072 nt
    s_add_u32 s45, s45, 16384
    ds_read_b128 v[32:35], v6 offset:64
    v_and_b32 v36, v28, v12
    v_and_b32 v37, v28, v13
    v_and_b32 v38, v28, v14
    v_and_b32 v39, v28, v15
    v_and_b32 v40, v29, v12
    v_and_b32 v41, v29, v13
    v_and_b32 v42, v29, v14
    v_and_b32 v43, v29, v15
    v_mfma_f32_16x16x32_bf16 v[24:27], v[64:67], v[36:39], v[24:27]
    v_and_b32 v36, v30, v12
    v_and_b32 v37, v30, v13
    v_and_b32 v38, v30, v14
    v_and_b32 v39, v30, v15
    v_mfma_f32_16x16x32_bf16 v[24:27], v[68:71], v[40:43], v[24:27]
    v_and_b32 v40, v31, v12
    v_and_b32 v41, v31, v13
    v_and_b32 v42, v31, v14
    v_and_b32 v43, v31, v15
    v_mfma_f32_16x16x32_bf16 v[24:27], v[72:75], v[36:39], v[24:27]
    s_nop 0
    v_mfma_f32_16x16x32_bf16 v[24:27], v[76:79], v[40:43], v[24:27]
    s_waitcnt vmcnt(0) lgkmcnt(0)
    buffer_load_dwordx4 v[96:99], v226, s[40:43], s45 offen offset:0 nt
    buffer_load_dwordx4 v[100:103], v226, s[40:43], s45 offen offset:1024 nt
    buffer_load_dwordx4 v[104:107], v226, s[40:43], s45 offen offset:2048 nt
    buffer_load_dwordx4 v[108:111], v226, s[40:43], s45 offen offset:3072 nt
    s_add_u32 s45, s45, 16384
    ds_read_b128 v[28:31], v6 offset:128
    v_and_b32 v36, v32, v12
    v_and_b32 v37, v32, v13
    v_and_b32 v38, v32, v14
    v_and_b32 v39, v32, v15
    v_and_b32 v40, v33, v12
    v_and_b32 v41, v33, v13
    v_and_b32 v42, v33, v14
    v_and_b32 v43, v33, v15
    v_mfma_f32_16x16x32_bf16 v[24:27], v[80:83], v[36:39], v[24:27]
    v_and_b32 v36, v34, v12
    v_and_b32 v37, v34, v13
    v_and_b32 v38, v34, v14
    v_and_b32 v39, v34, v15
    v_mfma_f32_16x16x32_bf16 v[24:27], v[84:87], v[40:43], v[24:27]
    v_and_b32 v40, v35, v12
    v_and_b32 v41, v35, v13
    v_and_b32 v42, v35, v14
    v_and_b32 v43, v35, v15
    v_mfma_f32_16x16x32_bf16 v[24:27], v[88:91], v[36:39], v[24:27]
    s_nop 0
    v_mfma_f32_16x16x32_bf16 v[24:27], v[92:95], v[40:43], v[24:27]
    ds_read_b32 v229, v228 offset:8
    s_waitcnt vmcnt(0) lgkmcnt(0)
    buffer_load_dwordx4 v[112:115], v227, s[40:43], s45 offen offset:0 nt
    buffer_load_dwordx4 v[116:119], v227, s[40:43], s45 offen offset:1024 nt
    buffer_load_dwordx4 v[120:123], v227, s[40:43], s45 offen offset:2048 nt
    buffer_load_dwordx4 v[124:127], v227, s[40:43], s45 offen offset:3072 nt
    s_add_u32 s45, s45, 16384
    ds_read_b128 v[32:35], v6 offset:192
    v_and_b32 v36, v28, v12
    v_and_b32 v37, v28, v13
    v_and_b32 v38, v28, v14
    v_and_b32 v39, v28, v15
    v_and_b32 v40, v29, v12
    v_and_b32 v41, v29, v13
    v_and_b32 v42, v29, v14
    v_and_b32 v43, v29, v15
    v_mfma_f32_16x16x32_bf16 v[24:27], v[96:99], v[36:39], v[24:27]
    v_and_b32 v36, v30, v12
    v_and_b32 v37, v30, v13
    v_and_b32 v38, v30, v14
    v_and_b32 v39, v30, v15
    v_mfma_f32_16x16x32_bf16 v[24:27], v[100:103], v[40:43], v[24:27]
    v_and_b32 v40, v31, v12
    v_and_b32 v41, v31, v13
    v_and_b32 v42, v31, v14
    v_and_b32 v43, v31, v15
    v_mfma_f32_16x16x32_bf16 v[24:27], v[104:107], v[36:39], v[24:27]
    s_nop 0
    v_mfma_f32_16x16x32_bf16 v[24:27], v[108:111], v[40:43], v[24:27]
    s_waitcnt vmcnt(0) lgkmcnt(0)
    buffer_load_dwordx4 v[64:67], v224, s[40:43], s45 offen offset:0 nt
    buffer_load_dwordx4 v[68:71], v224, s[40:43], s45 offen offset:1024 nt
    buffer_load_dwordx4 v[72:75], v224, s[40:43], s45 offen offset:2048 nt
    buffer_load_dwordx4 v[76:79], v224, s[40:43], s45 offen offset:3072 nt
    s_add_u32 s45, s45, 16384
    ds_read_b128 v[28:31], v6 offset:256
    v_and_b32 v36, v32, v12
    v_and_b32 v37, v32, v13
    v_and_b32 v38, v32, v14
    v_and_b32 v39, v32, v15
    v_and_b32 v40, v33, v12
    v_and_b32 v41, v33, v13
    v_and_b32 v42, v33, v14
    v_and_b32 v43, v33, v15
    v_mfma_f32_16x16x32_bf16 v[24:27], v[112:115], v[36:39], v[24:27]
    v_and_b32 v36, v34, v12
    v_and_b32 v37, v34, v13
    v_and_b32 v38, v34, v14
    v_and_b32 v39, v34, v15
    v_mfma_f32_16x16x32_bf16 v[24:27], v[116:119], v[40:43], v[24:27]
    v_and_b32 v40, v35, v12
    v_and_b32 v41, v35, v13
    v_and_b32 v42, v35, v14
    v_and_b32 v43, v35, v15
    v_mfma_f32_16x16x32_bf16 v[24:27], v[120:123], v[36:39], v[24:27]
    s_nop 0
    v_mfma_f32_16x16x32_bf16 v[24:27], v[124:127], v[40:43], v[24:27]
    v_add_u32 v6, 256, v6
    s_add_u32 s47, s47, 1
    s_cmp_lt_u32 s47, 16
    s_cbranch_scc1 L_vit
    s_branch L_vdone
L_vbody1:
    s_waitcnt vmcnt(0) lgkmcnt(0)
    buffer_load_dwordx4 v[80:83], v225, s[40:43], s45 offen offset:0 nt
    buffer_load_dwordx4 v[84:87], v225, s[40:43], s45 offen offset:1024 nt
    buffer_load_dwordx4 v[88:91], v225, s[40:43], s45 offen offset:2048 nt
    buffer_load_dwordx4 v[92:95], v225, s[40:43], s45 offen offset:3072 nt
    s_add_u32 s45, s45, 16384
    buffer_load_dwordx4 v[96:99], v226, s[40:43], s45 offen offset:0 nt
    buffer_load_dwordx4 v[100:103], v226, s[40:43], s45 offen offset:1024 nt
    buffer_load_dwordx4 v[104:107], v226, s[40:43], s45 offen offset:2048 nt
    buffer_load_dwordx4 v[108:111], v226, s[40:43], s45 offen offset:3072 nt
    s_add_u32 s45, s45, 16384
    ds_read_b128 v[32:35], v6 offset:64
    v_and_b32 v36, v28, v12
    v_and_b32 v37, v28, v13
    v_and_b32 v38, v28, v14
    v_and_b32 v39, v28, v15
    v_and_b32 v40, v29, v12
    v_and_b32 v41, v29, v13
    v_and_b32 v42, v29, v14
    v_and_b32 v43, v29, v15
    v_mfma_f32_16x16x32_bf16 v[24:27], v[64:67], v[36:39], v[24:27]
    v_and_b32 v36, v30, v12
    v_and_b32 v37, v30, v13
    v_and_b32 v38, v30, v14
    v_and_b32 v39, v30, v15
    v_mfma_f32_16x16x32_bf16 v[24:27], v[68:71], v[40:43], v[24:27]
    v_and_b32 v40, v31, v12
    v_and_b32 v41, v31, v13
    v_and_b32 v42, v31, v14
    v_and_b32 v43, v31, v15
    v_mfma_f32_16x16x32_bf16 v[24:27], v[72:75], v[36:39], v[24:27]
    s_nop 0
    v_mfma_f32_16x16x32_bf16 v[24:27], v[76:79], v[40:43], v[24:27]
    s_waitcnt vmcnt(4) lgkmcnt(0)
    ds_read_b128 v[28:31], v6 offset:128
    v_and_b32 v36, v32, v12
    v_and_b32 v37, v32, v13
    v_and_b32 v38, v32, v14
    v_and_b32 v39, v32, v15
    v_and_b32 v40, v33, v12
    v_and_b32 v41, v33, v13
    v_and_b32 v42, v33, v14
    v_and_b32 v43, v33, v15
    v_mfma_f32_16x16x32_bf16 v[24:27], v[80:83], v[36:39], v[24:27]
    v_and_b32 v36, v34, v12
    v_and_b32 v37, v34, v13
    v_and_b32 v38, v34, v14
    v_and_b32 v39, v34, v15
    v_mfma_f32_16x16x32_bf16 v[24:27], v[84:87], v[40:43], v[24:27]
    v_and_b32 v40, v35, v12
    v_and_b32 v41, v35, v13
    v_and_b32 v42, v35, v14
    v_and_b32 v43, v35, v15
    v_mfma_f32_16x16x32_bf16 v[24:27], v[88:91], v[36:39], v[24:27]
    s_nop 0
    v_mfma_f32_16x16x32_bf16 v[24:27], v[92:95], v[40:43], v[24:27]
    ds_read_b32 v229, v228 offset:8
    s_waitcnt vmcnt(0) lgkmcnt(0)
    buffer_load_dwordx4 v[112:115], v227, s[40:43], s45 offen offset:0 nt
    buffer_load_dwordx4 v[116:119], v227, s[40:43], s45 offen offset:1024 nt
    buffer_load_dwordx4 v[120:123], v227, s[40:43], s45 offen offset:2048 nt
    buffer_load_dwordx4 v[124:127], v227, s[40:43], s45 offen offset:3072 nt
    s_add_u32 s45, s45, 16384
    ds_read_b128 v[32:35], v6 offset:192
    v_and_b32 v36, v28, v12
    v_and_b32 v37, v28, v13
    v_and_b32 v38, v28, v14
    v_and_b32 v39, v28, v15
    v_and_b32 v40, v29, v12
    v_and_b32 v41, v29, v13
    v_and_b32 v42, v29, v14
    v_and_b32 v43, v29, v15
    v_mfma_f32_16x16x32_bf16 v[24:27], v[96:99], v[36:39], v[24:27]
    v_and_b32 v36, v30, v12
    v_and_b32 v37, v30, v13
    v_and_b32 v38, v30, v14
    v_and_b32 v39, v30, v15
    v_mfma_f32_16x16x32_bf16 v[24:27], v[100:103], v[40:43], v[24:27]
    v_and_b32 v40, v31, v12
    v_and_b32 v41, v31, v13
    v_and_b32 v42, v31, v14
    v_and_b32 v43, v31, v15
    v_mfma_f32_16x16x32_bf16 v[24:27], v[104:107], v[36:39], v[24:27]
    s_nop 0
    v_mfma_f32_16x16x32_bf16 v[24:27], v[108:111], v[40:43], v[24:27]
    s_waitcnt vmcnt(0) lgkmcnt(0)
    buffer_load_dwordx4 v[64:67], v224, s[40:43], s45 offen offset:0 nt
    buffer_load_dwordx4 v[68:71], v224, s[40:43], s45 offen offset:1024 nt
    buffer_load_dwordx4 v[72:75], v224, s[40:43], s45 offen offset:2048 nt
    buffer_load_dwordx4 v[76:79], v224, s[40:43], s45 offen offset:3072 nt
    s_add_u32 s45, s45, 16384
    ds_read_b128 v[28:31], v6 offset:256
    v_and_b32 v36, v32, v12
    v_and_b32 v37, v32, v13
    v_and_b32 v38, v32, v14
    v_and_b32 v39, v32, v15
    v_and_b32 v40, v33, v12
    v_and_b32 v41, v33, v13
    v_and_b32 v42, v33, v14
    v_and_b32 v43, v33, v15
    v_mfma_f32_16x16x32_bf16 v[24:27], v[112:115], v[36:39], v[24:27]
    v_and_b32 v36, v34, v12
    v_and_b32 v37, v34, v13
    v_and_b32 v38, v34, v14
    v_and_b32 v39, v34, v15
    v_mfma_f32_16x16x32_bf16 v[24:27], v[116:119], v[40:43], v[24:27]
    v_and_b32 v40, v35, v12
    v_and_b32 v41, v35, v13
    v_and_b32 v42, v35, v14
    v_and_b32 v43, v35, v15
    v_mfma_f32_16x16x32_bf16 v[24:27], v[120:123], v[36:39], v[24:27]
    s_nop 0
    v_mfma_f32_16x16x32_bf16 v[24:27], v[124:127], v[40:43], v[24:27]
    v_add_u32 v6, 256, v6
    s_add_u32 s47, s47, 1
    s_cmp_lt_u32 s47, 16
    s_cbranch_scc1 L_vit
    s_branch L_vdone
L_vbody2:
    s_waitcnt vmcnt(0) lgkmcnt(0)
    buffer_load_dwordx4 v[80:83], v225, s[40:43], s45 offen offset:0 nt
    buffer_load_dwordx4 v[84:87], v225, s[40:43], s45 offen offset:1024 nt
    buffer_load_dwordx4 v[88:91], v225, s[40:43], s45 offen offset:2048 nt
    buffer_load_dwordx4 v[92:95], v225, s[40:43], s45 offen offset:3072 nt
    s_add_u32 s45, s45, 16384
    buffer_load_dwordx4 v[96:99], v226, s[40:43], s45 offen offset:0 nt
    buffer_load_dwordx4 v[100:103], v226, s[40:43], s45 offen offset:1024 nt
    buffer_load_dwordx4 v[104:107], v226, s[40:43], s45 offen offset:2048 nt
    buffer_load_dwordx4 v[108:111], v226, s[40:43], s45 offen offset:3072 nt
    s_add_u32 s45, s45, 16384
    ds_read_b128 v[32:35], v6 offset:64
    v_and_b32 v36, v28, v12
    v_and_b32 v37, v28, v13
    v_and_b32 v38, v28, v14
    v_and_b32 v39, v28, v15
    v_and_b32 v40, v29, v12
    v_and_b32 v41, v29, v13
    v_and_b32 v42, v29, v14
    v_and_b32 v43, v29, v15
    v_mfma_f32_16x16x32_bf16 v[24:27], v[64:67], v[36:39], v[24:27]
    v_and_b32 v36, v30, v12
    v_and_b32 v37, v30, v13
    v_and_b32 v38, v30, v14
    v_and_b32 v39, v30, v15
    v_mfma_f32_16x16x32_bf16 v[24:27], v[68:71], v[40:43], v[24:27]
    v_and_b32 v40, v31, v12
    v_and_b32 v41, v31, v13
    v_and_b32 v42, v31, v14
    v_and_b32 v43, v31, v15
    v_mfma_f32_16x16x32_bf16 v[24:27], v[72:75], v[36:39], v[24:27]
    s_nop 0
    v_mfma_f32_16x16x32_bf16 v[24:27], v[76:79], v[40:43], v[24:27]
    s_waitcnt vmcnt(4) lgkmcnt(0)
    buffer_load_dwordx4 v[112:115], v227, s[40:43], s45 offen offset:0 nt
    buffer_load_dwordx4 v[116:119], v227, s[40:43], s45 offen offset:1024 nt
    buffer_load_dwordx4 v[120:123], v227, s[40:43], s45 offen offset:2048 nt
    buffer_load_dwordx4 v[124:127], v227, s[40:43], s45 offen offset:3072 nt
    s_add_u32 s45, s45, 16384
    ds_read_b128 v[28:31], v6 offset:128
    v_and_b32 v36, v32, v12
    v_and_b32 v37, v32, v13
    v_and_b32 v38, v32, v14
    v_and_b32 v39, v32, v15
    v_and_b32 v40, v33, v12
    v_and_b32 v41, v33, v13
    v_and_b32 v42, v33, v14
    v_and_b32 v43, v33, v15
    v_mfma_f32_16x16x32_bf16 v[24:27], v[80:83], v[36:39], v[24:27]
    v_and_b32 v36, v34, v12
    v_and_b32 v37, v34, v13
    v_and_b32 v38, v34, v14
    v_and_b32 v39, v34, v15
    v_mfma_f32_16x16x32_bf16 v[24:27], v[84:87], v[40:43], v[24:27]
    v_and_b32 v40, v35, v12
    v_and_b32 v41, v35, v13
    v_and_b32 v42, v35, v14
    v_and_b32 v43, v35, v15
    v_mfma_f32_16x16x32_bf16 v[24:27], v[88:91], v[36:39], v[24:27]
    s_nop 0
    v_mfma_f32_16x16x32_bf16 v[24:27], v[92:95], v[40:43], v[24:27]
    ds_read_b32 v229, v228 offset:8
    s_waitcnt vmcnt(4) lgkmcnt(0)
    ds_read_b128 v[32:35], v6 offset:192
    v_and_b32 v36, v28, v12
    v_and_b32 v37, v28, v13
    v_and_b32 v38, v28, v14
    v_and_b32 v39, v28, v15
    v_and_b32 v40, v29, v12
    v_and_b32 v41, v29, v13
    v_and_b32 v42, v29, v14
    v_and_b32 v43, v29, v15
    v_mfma_f32_16x16x32_bf16 v[24:27], v[96:99], v[36:39], v[24:27]
    v_and_b32 v36, v30, v12
    v_and_b32 v37, v30, v13
    v_and_b32 v38, v30, v14
    v_and_b32 v39, v30, v15
    v_mfma_f32_16x16x32_bf16 v[24:27], v[100:103], v[40:43], v[24:27]
    v_and_b32 v40, v31, v12
    v_and_b32 v41, v31, v13
    v_and_b32 v42, v31, v14
    v_and_b32 v43, v31, v15
    v_mfma_f32_16x16x32_bf16 v[24:27], v[104:107], v[36:39], v[24:27]
    s_nop 0
    v_mfma_f32_16x16x32_bf16 v[24:27], v[108:111], v[40:43], v[24:27]
    s_waitcnt vmcnt(0) lgkmcnt(0)
    buffer_load_dwordx4 v[64:67], v224, s[40:43], s45 offen offset:0 nt
    buffer_load_dwordx4 v[68:71], v224, s[40:43], s45 offen offset:1024 nt
    buffer_load_dwordx4 v[72:75], v224, s[40:43], s45 offen offset:2048 nt
    buffer_load_dwordx4 v[76:79], v224, s[40:43], s45 offen offset:3072 nt
    s_add_u32 s45, s45, 16384
    ds_read_b128 v[28:31], v6 offset:256
    v_and_b32 v36, v32, v12
    v_and_b32 v37, v32, v13
    v_and_b32 v38, v32, v14
    v_and_b32 v39, v32, v15
    v_and_b32 v40, v33, v12
    v_and_b32 v41, v33, v13
    v_and_b32 v42, v33, v14
    v_and_b32 v43, v33, v15
    v_mfma_f32_16x16x32_bf16 v[24:27], v[112:115], v[36:39], v[24:27]
    v_and_b32 v36, v34, v12
    v_and_b32 v37, v34, v13
    v_and_b32 v38, v34, v14
    v_and_b32 v39, v34, v15
    v_mfma_f32_16x16x32_bf16 v[24:27], v[116:119], v[40:43], v[24:27]
    v_and_b32 v40, v35, v12
    v_and_b32 v41, v35, v13
    v_and_b32 v42, v35, v14
    v_and_b32 v43, v35, v15
    v_mfma_f32_16x16x32_bf16 v[24:27], v[120:123], v[36:39], v[24:27]
    s_nop 0
    v_mfma_f32_16x16x32_bf16 v[24:27], v[124:127], v[40:43], v[24:27]
    v_add_u32 v6, 256, v6
    s_add_u32 s47, s47, 1
    s_cmp_lt_u32 s47, 16
    s_cbranch_scc1 L_vit
    s_branch L_vdone
L_vbody3:
    s_waitcnt vmcnt(0) lgkmcnt(0)
    buffer_load_dwordx4 v[80:83], v225, s[40:43], s45 offen offset:0 nt
    buffer_load_dwordx4 v[84:87], v225, s[40:43], s45 offen offset:1024 nt
    buffer_load_dwordx4 v[88:91], v225, s[40:43], s45 offen offset:2048 nt
    buffer_load_dwordx4 v[92:95], v225, s[40:43], s45 offen offset:3072 nt
    s_add_u32 s45, s45, 16384
    buffer_load_dwordx4 v[96:99], v226, s[40:43], s45 offen offset:0 nt
    buffer_load_dwordx4 v[100:103], v226, s[40:43], s45 offen offset:1024 nt
    buffer_load_dwordx4 v[104:107], v226, s[40:43], s45 offen offset:2048 nt
    buffer_load_dwordx4 v[108:111], v226, s[40:43], s45 offen offset:3072 nt
    s_add_u32 s45, s45, 16384
    ds_read_b128 v[32:35], v6 offset:64
    v_and_b32 v36, v28, v12
    v_and_b32 v37, v28, v13
    v_and_b32 v38, v28, v14
    v_and_b32 v39, v28, v15
    v_and_b32 v40, v29, v12
    v_and_b32 v41, v29, v13
    v_and_b32 v42, v29, v14
    v_and_b32 v43, v29, v15
    v_mfma_f32_16x16x32_bf16 v[24:27], v[64:67], v[36:39], v[24:27]
    v_and_b32 v36, v30, v12
    v_and_b32 v37, v30, v13
    v_and_b32 v38, v30, v14
    v_and_b32 v39, v30, v15
    v_mfma_f32_16x16x32_bf16 v[24:27], v[68:71], v[40:43], v[24:27]
    v_and_b32 v40, v31, v12
    v_and_b32 v41, v31, v13
    v_and_b32 v42, v31, v14
    v_and_b32 v43, v31, v15
    v_mfma_f32_16x16x32_bf16 v[24:27], v[72:75], v[36:39], v[24:27]
    s_nop 0
    v_mfma_f32_16x16x32_bf16 v[24:27], v[76:79], v[40:43], v[24:27]
    s_waitcnt vmcnt(4) lgkmcnt(0)
    buffer_load_dwordx4 v[112:115], v227, s[40:43], s45 offen offset:0 nt
    buffer_load_dwordx4 v[116:119], v227, s[40:43], s45 offen offset:1024 nt
    buffer_load_dwordx4 v[120:123], v227, s[40:43], s45 offen offset:2048 nt
    buffer_load_dwordx4 v[124:127], v227, s[40:43], s45 offen offset:3072 nt
    s_add_u32 s45, s45, 16384
    ds_read_b128 v[28:31], v6 offset:128
    v_and_b32 v36, v32, v12
    v_and_b32 v37, v32, v13
    v_and_b32 v38, v32, v14
    v_and_b32 v39, v32, v15
    v_and_b32 v40, v33, v12
    v_and_b32 v41, v33, v13
    v_and_b32 v42, v33, v14
    v_and_b32 v43, v33, v15
    v_mfma_f32_16x16x32_bf16 v[24:27], v[80:83], v[36:39], v[24:27]
    v_and_b32 v36, v34, v12
    v_and_b32 v37, v34, v13
    v_and_b32 v38, v34, v14
    v_and_b32 v39, v34, v15
    v_mfma_f32_16x16x32_bf16 v[24:27], v[84:87], v[40:43], v[24:27]
    v_and_b32 v40, v35, v12
    v_and_b32 v41, v35, v13
    v_and_b32 v42, v35, v14
    v_and_b32 v43, v35, v15
    v_mfma_f32_16x16x32_bf16 v[24:27], v[88:91], v[36:39], v[24:27]
    s_nop 0
    v_mfma_f32_16x16x32_bf16 v[24:27], v[92:95], v[40:43], v[24:27]
    ds_read_b32 v229, v228 offset:8
    s_waitcnt vmcnt(4) lgkmcnt(0)
    buffer_load_dwordx4 v[64:67], v224, s[40:43], s45 offen offset:0 nt
    buffer_load_dwordx4 v[68:71], v224, s[40:43], s45 offen offset:1024 nt
    buffer_load_dwordx4 v[72:75], v224, s[40:43], s45 offen offset:2048 nt
    buffer_load_dwordx4 v[76:79], v224, s[40:43], s45 offen offset:3072 nt
    s_add_u32 s45, s45, 16384
    ds_read_b128 v[32:35], v6 offset:192
    v_and_b32 v36, v28, v12
    v_and_b32 v37, v28, v13
    v_and_b32 v38, v28, v14
    v_and_b32 v39, v28, v15
    v_and_b32 v40, v29, v12
    v_and_b32 v41, v29, v13
    v_and_b32 v42, v29, v14
    v_and_b32 v43, v29, v15
    v_mfma_f32_16x16x32_bf16 v[24:27], v[96:99], v[36:39], v[24:27]
    v_and_b32 v36, v30, v12
    v_and_b32 v37, v30, v13
    v_and_b32 v38, v30, v14
    v_and_b32 v39, v30, v15
    v_mfma_f32_16x16x32_bf16 v[24:27], v[100:103], v[40:43], v[24:27]
    v_and_b32 v40, v31, v12
    v_and_b32 v41, v31, v13
    v_and_b32 v42, v31, v14
    v_and_b32 v43, v31, v15
    v_mfma_f32_16x16x32_bf16 v[24:27], v[104:107], v[36:39], v[24:27]
    s_nop 0
    v_mfma_f32_16x16x32_bf16 v[24:27], v[108:111], v[40:43], v[24:27]
    s_waitcnt vmcnt(4) lgkmcnt(0)
    ds_read_b128 v[28:31], v6 offset:256
    v_and_b32 v36, v32, v12
    v_and_b32 v37, v32, v13
    v_and_b32 v38, v32, v14
    v_and_b32 v39, v32, v15
    v_and_b32 v40, v33, v12
    v_and_b32 v41, v33, v13
    v_and_b32 v42, v33, v14
    v_and_b32 v43, v33, v15
    v_mfma_f32_16x16x32_bf16 v[24:27], v[112:115], v[36:39], v[24:27]
    v_and_b32 v36, v34, v12
    v_and_b32 v37, v34, v13
    v_and_b32 v38, v34, v14
    v_and_b32 v39, v34, v15
    v_mfma_f32_16x16x32_bf16 v[24:27], v[116:119], v[40:43], v[24:27]
    v_and_b32 v40, v35, v12
    v_and_b32 v41, v35, v13
    v_and_b32 v42, v35, v14
    v_and_b32 v43, v35, v15
    v_mfma_f32_16x16x32_bf16 v[24:27], v[120:123], v[36:39], v[24:27]
    s_nop 0
    v_mfma_f32_16x16x32_bf16 v[24:27], v[124:127], v[40:43], v[24:27]
    v_add_u32 v6, 256, v6
    s_add_u32 s47, s47, 1
    s_cmp_lt_u32 s47, 16
    s_cbranch_scc1 L_vit
    s_branch L_vdone
L_vbody4:
    s_waitcnt vmcnt(0) lgkmcnt(0)
    buffer_load_dwordx4 v[80:83], v225, s[40:43], s45 offen offset:0 nt
    buffer_load_dwordx4 v[84:87], v225, s[40:43], s45 offen offset:1024 nt
    buffer_load_dwordx4 v[88:91], v225, s[40:43], s45 offen offset:2048 nt
    buffer_load_dwordx4 v[92:95], v225, s[40:43], s45 offen offset:3072 nt
    s_add_u32 s45, s45, 16384
    buffer_load_dwordx4 v[96:99], v226, s[40:43], s45 offen offset:0 nt
    buffer_load_dwordx4 v[100:103], v226, s[40:43], s45 offen offset:1024 nt
    buffer_load_dwordx4 v[104:107], v226, s[40:43], s45 offen offset:2048 nt
    buffer_load_dwordx4 v[108:111], v226, s[40:43], s45 offen offset:3072 nt
    s_add_u32 s45, s45, 16384
    buffer_load_dwordx4 v[112:115], v227, s[40:43], s45 offen offset:0 nt
    buffer_load_dwordx4 v[116:119], v227, s[40:43], s45 offen offset:1024 nt
    buffer_load_dwordx4 v[120:123], v227, s[40:43], s45 offen offset:2048 nt
    buffer_load_dwordx4 v[124:127], v227, s[40:43], s45 offen offset:3072 nt
    s_add_u32 s45, s45, 16384
    ds_read_b128 v[32:35], v6 offset:64
    v_and_b32 v36, v28, v12
    v_and_b32 v37, v28, v13
    v_and_b32 v38, v28, v14
    v_and_b32 v39, v28, v15
    v_and_b32 v40, v29, v12
    v_and_b32 v41, v29, v13
    v_and_b32 v42, v29, v14
    v_and_b32 v43, v29, v15
    v_mfma_f32_16x16x32_bf16 v[24:27], v[64:67], v[36:39], v[24:27]
    v_and_b32 v36, v30, v12
    v_and_b32 v37, v30, v13
    v_and_b32 v38, v30, v14
    v_and_b32 v39, v30, v15
    v_mfma_f32_16x16x32_bf16 v[24:27], v[68:71], v[40:43], v[24:27]
    v_and_b32 v40, v31, v12
    v_and_b32 v41, v31, v13
    v_and_b32 v42, v31, v14
    v_and_b32 v43, v31, v15
    v_mfma_f32_16x16x32_bf16 v[24:27], v[72:75], v[36:39], v[24:27]
    s_nop 0
    v_mfma_f32_16x16x32_bf16 v[24:27], v[76:79], v[40:43], v[24:27]
    s_waitcnt vmcnt(8) lgkmcnt(0)
    buffer_load_dwordx4 v[64:67], v224, s[40:43], s45 offen offset:0 nt
    buffer_load_dwordx4 v[68:71], v224, s[40:43], s45 offen offset:1024 nt
    buffer_load_dwordx4 v[72:75], v224, s[40:43], s45 offen offset:2048 nt
    buffer_load_dwordx4 v[76:79], v224, s[40:43], s45 offen offset:3072 nt
    s_add_u32 s45, s45, 16384
    ds_read_b128 v[28:31], v6 offset:128
    v_and_b32 v36, v32, v12
    v_and_b32 v37, v32, v13
    v_and_b32 v38, v32, v14
    v_and_b32 v39, v32, v15
    v_and_b32 v40, v33, v12
    v_and_b32 v41, v33, v13
    v_and_b32 v42, v33, v14
    v_and_b32 v43, v33, v15
    v_mfma_f32_16x16x32_bf16 v[24:27], v[80:83], v[36:39], v[24:27]
    v_and_b32 v36, v34, v12
    v_and_b32 v37, v34, v13
    v_and_b32 v38, v34, v14
    v_and_b32 v39, v34, v15
    v_mfma_f32_16x16x32_bf16 v[24:27], v[84:87], v[40:43], v[24:27]
    v_and_b32 v40, v35, v12
    v_and_b32 v41, v35, v13
    v_and_b32 v42, v35, v14
    v_and_b32 v43, v35, v15
    v_mfma_f32_16x16x32_bf16 v[24:27], v[88:91], v[36:39], v[24:27]
    s_nop 0
    v_mfma_f32_16x16x32_bf16 v[24:27], v[92:95], v[40:43], v[24:27]
    ds_read_b32 v229, v228 offset:8
    s_waitcnt vmcnt(8) lgkmcnt(0)
    ds_read_b128 v[32:35], v6 offset:192
    v_and_b32 v36, v28, v12
    v_and_b32 v37, v28, v13
    v_and_b32 v38, v28, v14
    v_and_b32 v39, v28, v15
    v_and_b32 v40, v29, v12
    v_and_b32 v41, v29, v13
    v_and_b32 v42, v29, v14
    v_and_b32 v43, v29, v15
    v_mfma_f32_16x16x32_bf16 v[24:27], v[96:99], v[36:39], v[24:27]
    v_and_b32 v36, v30, v12
    v_and_b32 v37, v30, v13
    v_and_b32 v38, v30, v14
    v_and_b32 v39, v30, v15
    v_mfma_f32_16x16x32_bf16 v[24:27], v[100:103], v[40:43], v[24:27]
    v_and_b32 v40, v31, v12
    v_and_b32 v41, v31, v13
    v_and_b32 v42, v31, v14
    v_and_b32 v43, v31, v15
    v_mfma_f32_16x16x32_bf16 v[24:27], v[104:107], v[36:39], v[24:27]
    s_nop 0
    v_mfma_f32_16x16x32_bf16 v[24:27], v[108:111], v[40:43], v[24:27]
    s_waitcnt vmcnt(4) lgkmcnt(0)
    ds_read_b128 v[28:31], v6 offset:256
    v_and_b32 v36, v32, v12
    v_and_b32 v37, v32, v13
    v_and_b32 v38, v32, v14
    v_and_b32 v39, v32, v15
    v_and_b32 v40, v33, v12
    v_and_b32 v41, v33, v13
    v_and_b32 v42, v33, v14
    v_and_b32 v43, v33, v15
    v_mfma_f32_16x16x32_bf16 v[24:27], v[112:115], v[36:39], v[24:27]
    v_and_b32 v36, v34, v12
    v_and_b32 v37, v34, v13
    v_and_b32 v38, v34, v14
    v_and_b32 v39, v34, v15
    v_mfma_f32_16x16x32_bf16 v[24:27], v[116:119], v[40:43], v[24:27]
    v_and_b32 v40, v35, v12
    v_and_b32 v41, v35, v13
    v_and_b32 v42, v35, v14
    v_and_b32 v43, v35, v15
    v_mfma_f32_16x16x32_bf16 v[24:27], v[120:123], v[36:39], v[24:27]
    s_nop 0
    v_mfma_f32_16x16x32_bf16 v[24:27], v[124:127], v[40:43], v[24:27]
    v_add_u32 v6, 256, v6
    s_add_u32 s47, s47, 1
    s_cmp_lt_u32 s47, 16
    s_cbranch_scc1 L_vit
    s_branch L_vdone
L_vdone:
    s_waitcnt vmcnt(0) lgkmcnt(0)
L_vtail:
    v_lshlrev_b32 v44, 7, v2
    v_lshl_or_b32 v44, v1, 2, v44
    s_lshl_b32 s46, s32, 9
    v_add_u32 v44, s46, v44
    s_lshl_b32 s46, s32, 3
    v_mov_b32 v45, s46
    s_nop 7
    s_mov_b32 exec_lo, 0x00ff00ff
    s_mov_b32 exec_hi, 0x00ff00ff
    ds_write_b32 v44, v24 offset:20480
    ds_write_b32 v44, v25 offset:20512
    ds_write_b32 v44, v26 offset:20544
    ds_write_b32 v44, v27 offset:20576
    s_mov_b64 exec, -1
    s_waitcnt lgkmcnt(0)
    s_barrier
    v_mov_b32 v44, 22592
    s_cmp_eq_u32 s32, 0
    s_cbranch_scc0 L_tspin
    s_lshl_b32 s54, s30, 5
    s_mov_b32 s48, s26
    s_mov_b32 s49, s27
    s_mov_b32 s50, 256
    s_mov_b32 s51, 0x20000
    v_mov_b32 v45, s54
    v_mov_b32 v46, 1
    s_mov_b64 exec, 1
    buffer_atomic_add v46, v45, s[48:51], 0 offen sc0
    s_waitcnt vmcnt(0)
    ds_write_b32 v44, v46 offset:12
    s_mov_b64 exec, -1
L_tspin:
    ds_read_b32 v46, v44 offset:12
    s_waitcnt lgkmcnt(0)
    v_readfirstlane_b32 s60, v46
    s_nop 3
    s_cmp_eq_u32 s60, -1
    s_cbranch_scc1 L_tspin
    s_cmp_eq_u32 s60, 31
    s_cbranch_scc0 L_join
    s_lshl_b32 s52, s32, 9
    s_mul_i32 s53, s30, 81920
    s_add_u32 s36, s28, s53
    s_addc_u32 s37, s29, 0
    s_mov_b32 s38, 81920
    s_mov_b32 s39, 0x20000
    v_lshrrev_b32 v47, 5, v0
    v_mul_u32_u24 v47, 2560, v47
    v_and_b32 v46, 31, v0
    v_lshl_add_u32 v47, v46, 4, v47
    s_mov_b32 s53, s52
    buffer_load_dwordx4 v[128:131], v47, s[36:39], s53 offen sc1
    s_add_u32 s53, s53, 5120
    buffer_load_dwordx4 v[132:135], v47, s[36:39], s53 offen sc1
    s_add_u32 s53, s53, 5120
    buffer_load_dwordx4 v[136:139], v47, s[36:39], s53 offen sc1
    s_add_u32 s53, s53, 5120
    buffer_load_dwordx4 v[140:143], v47, s[36:39], s53 offen sc1
    s_add_u32 s53, s53, 5120
    buffer_load_dwordx4 v[144:147], v47, s[36:39], s53 offen sc1
    s_add_u32 s53, s53, 5120
    buffer_load_dwordx4 v[148:151], v47, s[36:39], s53 offen sc1
    s_add_u32 s53, s53, 5120
    buffer_load_dwordx4 v[152:155], v47, s[36:39], s53 offen sc1
    s_add_u32 s53, s53, 5120
    buffer_load_dwordx4 v[156:159], v47, s[36:39], s53 offen sc1
    s_add_u32 s53, s53, 5120
    buffer_load_dwordx4 v[160:163], v47, s[36:39], s53 offen sc1
    s_add_u32 s53, s53, 5120
    buffer_load_dwordx4 v[164:167], v47, s[36:39], s53 offen sc1
    s_add_u32 s53, s53, 5120
    buffer_load_dwordx4 v[168:171], v47, s[36:39], s53 offen sc1
    s_add_u32 s53, s53, 5120
    buffer_load_dwordx4 v[172:175], v47, s[36:39], s53 offen sc1
    s_add_u32 s53, s53, 5120
    buffer_load_dwordx4 v[176:179], v47, s[36:39], s53 offen sc1
    s_add_u32 s53, s53, 5120
    buffer_load_dwordx4 v[180:183], v47, s[36:39], s53 offen sc1
    s_add_u32 s53, s53, 5120
    buffer_load_dwordx4 v[184:187], v47, s[36:39], s53 offen sc1
    s_add_u32 s53, s53, 5120
    buffer_load_dwordx4 v[188:191], v47, s[36:39], s53 offen sc1
    v_lshrrev_b32 v49, 3, v0
    v_mul_u32_u24 v49, 2560, v49
    v_and_b32 v50, 7, v0
    v_lshl_add_u32 v49, v50, 4, v49
    s_lshl_b32 s54, s32, 7
    s_add_u32 s54, s54, 2048
    v_add_u32 v49, s54, v49
    s_mov_b32 s53, 0
    buffer_load_dwordx4 v[192:195], v49, s[36:39], s53 offen sc1
    s_mov_b32 s53, 20480
    buffer_load_dwordx4 v[196:199], v49, s[36:39], s53 offen sc1
    s_mov_b32 s53, 40960
    buffer_load_dwordx4 v[200:203], v49, s[36:39], s53 offen sc1
    s_mov_b32 s53, 61440
    buffer_load_dwordx4 v[204:207], v49, s[36:39], s53 offen sc1
    s_branch L_join
L_join:
    v_mov_b32 v44, 22592
    s_lshl_b32 s52, s32, 9
    v_and_b32 v3, 31, v0
    v_lshlrev_b32 v3, 4, v3
    v_add_u32 v3, s52, v3
    v_and_b32 v48, 7, v0
    v_lshlrev_b32 v48, 4, v48
    s_lshl_b32 s54, s32, 7
    s_add_u32 s54, s54, 2048
    v_add_u32 v48, s54, v48
    s_cmp_eq_u32 s60, 31
    s_cbranch_scc1 L_yspin
    s_mul_i32 s53, s30, 81920
    s_add_u32 s36, s28, s53
    s_addc_u32 s37, s29, 0
    s_mov_b32 s38, 81920
    s_mov_b32 s39, 0x20000
    s_mul_i32 s54, s31, 2560
    s_add_u32 s53, s54, s52
    s_lshl_b32 s55, s32, 7
    s_add_u32 s54, s54, s55
    s_add_u32 s54, s54, 2048
    v_lshlrev_b32 v4, 4, v0
L_yspin:
    ds_read_b32 v45, v44 offset:16
    s_waitcnt lgkmcnt(0)
    v_readfirstlane_b32 s62, v45
    s_nop 3
    s_cmp_ge_u32 s62, 4
    s_cbranch_scc0 L_yspin
    ds_read_b128 v[8:11], v3 offset:22656
    ds_read_b128 v[12:15], v3 offset:25216
    ds_read_b128 v[16:19], v3 offset:27776
    ds_read_b128 v[20:23], v3 offset:30336
    ds_read_b128 v[24:27], v48 offset:22656
    ds_read_b128 v[28:31], v48 offset:25216
    ds_read_b128 v[32:35], v48 offset:27776
    ds_read_b128 v[36:39], v48 offset:30336
    s_cmp_eq_u32 s60, 31
    s_cbranch_scc0 L_notlast
    s_lshr_b32 s56, s31, 1
    s_lshl_b32 s57, s56, 2
    s_bitcmp1_b32 s31, 0
    s_cselect_b32 s58, 0, -1
    s_cselect_b32 s59, -1, 0
    s_lshr_b32 s55, s31, 3
    s_lshl_b32 s55, s55, 2
    s_and_b32 s54, s31, 7
    s_lshl_b32 s54, s54, 3
    s_mov_b64 s[62:63], 0xff
    s_lshl_b64 s[62:63], s[62:63], s54
    s_mov_b32 s44, s24
    s_mov_b32 s45, s25
    s_mov_b32 s46, 10240
    s_mov_b32 s47, 0x20000
    s_mov_b32 s61, 0
    v_lshlrev_b32 v4, 3, v0
    s_waitcnt lgkmcnt(0)
    v_add_f32 v8, v8, v12
    v_add_f32 v16, v16, v20
    v_add_f32 v9, v9, v13
    v_add_f32 v17, v17, v21
    v_add_f32 v10, v10, v14
    v_add_f32 v18, v18, v22
    v_add_f32 v11, v11, v15
    v_add_f32 v19, v19, v23
    v_add_f32 v8, v8, v16
    v_add_f32 v9, v9, v17
    v_add_f32 v10, v10, v18
    v_add_f32 v11, v11, v19
    v_add_f32 v24, v24, v28
    v_add_f32 v32, v32, v36
    v_add_f32 v25, v25, v29
    v_add_f32 v33, v33, v37
    v_add_f32 v26, v26, v30
    v_add_f32 v34, v34, v38
    v_add_f32 v27, v27, v31
    v_add_f32 v35, v35, v39
    v_add_f32 v24, v24, v32
    v_add_f32 v25, v25, v33
    v_add_f32 v26, v26, v34
    v_add_f32 v27, v27, v35
L_ftry:
    s_waitcnt vmcnt(12)
    s_cmp_lt_u32 s56, 8
    s_cbranch_scc0 L_np0
    s_mov_b32 exec_lo, s58
    s_mov_b32 exec_hi, s59
    s_set_gpr_idx_on s57, 0x8
    v_mov_b32 v128, v8
    v_mov_b32 v129, v9
    v_mov_b32 v130, v10
    v_mov_b32 v131, v11
    s_set_gpr_idx_off
    s_mov_b64 exec, -1
L_np0:
    v_max3_i32 v44, v128, v129, v130
    v_max_i32 v44, v44, v131
    v_max3_i32 v44, v44, v132, v133
    v_max3_i32 v44, v44, v134, v135
    v_add_f32 v40, v128, v132
    v_add_f32 v41, v129, v133
    v_add_f32 v42, v130, v134
    v_add_f32 v43, v131, v135
    v_max3_i32 v44, v44, v136, v137
    v_max3_i32 v44, v44, v138, v139
    v_add_f32 v40, v40, v136
    v_add_f32 v41, v41, v137
    v_add_f32 v42, v42, v138
    v_add_f32 v43, v43, v139
    v_max3_i32 v44, v44, v140, v141
    v_max3_i32 v44, v44, v142, v143
    v_add_f32 v40, v40, v140
    v_add_f32 v41, v41, v141
    v_add_f32 v42, v42, v142
    v_add_f32 v43, v43, v143
    v_max3_i32 v44, v44, v144, v145
    v_max3_i32 v44, v44, v146, v147
    v_add_f32 v40, v40, v144
    v_add_f32 v41, v41, v145
    v_add_f32 v42, v42, v146
    v_add_f32 v43, v43, v147
    v_max3_i32 v44, v44, v148, v149
    v_max3_i32 v44, v44, v150, v151
    v_add_f32 v40, v40, v148
    v_add_f32 v41, v41, v149
    v_add_f32 v42, v42, v150
    v_add_f32 v43, v43, v151
    v_max3_i32 v44, v44, v152, v153
    v_max3_i32 v44, v44, v154, v155
    v_add_f32 v40, v40, v152
    v_add_f32 v41, v41, v153
    v_add_f32 v42, v42, v154
    v_add_f32 v43, v43, v155
    v_max3_i32 v44, v44, v156, v157
    v_max3_i32 v44, v44, v158, v159
    v_add_f32 v40, v40, v156
    v_add_f32 v41, v41, v157
    v_add_f32 v42, v42, v158
    v_add_f32 v43, v43, v159
    s_waitcnt vmcnt(4)
    s_cmp_lt_u32 s56, 8
    s_cbranch_scc1 L_np1
    s_mov_b32 exec_lo, s58
    s_mov_b32 exec_hi, s59
    s_set_gpr_idx_on s57, 0x8
    v_mov_b32 v128, v8
    v_mov_b32 v129, v9
    v_mov_b32 v130, v10
    v_mov_b32 v131, v11
    s_set_gpr_idx_off
    s_mov_b64 exec, -1
L_np1:
    v_max3_i32 v44, v44, v160, v161
    v_max3_i32 v44, v44, v162, v163
    v_add_f32 v40, v40, v160
    v_add_f32 v41, v41, v161
    v_add_f32 v42, v42, v162
    v_add_f32 v43, v43, v163
    v_max3_i32 v44, v44, v164, v165
    v_max3_i32 v44, v44, v166, v167
    v_add_f32 v40, v40, v164
    v_add_f32 v41, v41, v165
    v_add_f32 v42, v42, v166
    v_add_f32 v43, v43, v167
    v_max3_i32 v44, v44, v168, v169
    v_max3_i32 v44, v44, v170, v171
    v_add_f32 v40, v40, v168
    v_add_f32 v41, v41, v169
    v_add_f32 v42, v42, v170
    v_add_f32 v43, v43, v171
    v_max3_i32 v44, v44, v172, v173
    v_max3_i32 v44, v44, v174, v175
    v_add_f32 v40, v40, v172
    v_add_f32 v41, v41, v173
    v_add_f32 v42, v42, v174
    v_add_f32 v43, v43, v175
    v_max3_i32 v44, v44, v176, v177
    v_max3_i32 v44, v44, v178, v179
    v_add_f32 v40, v40, v176
    v_add_f32 v41, v41, v177
    v_add_f32 v42, v42, v178
    v_add_f32 v43, v43, v179
    v_max3_i32 v44, v44, v180, v181
    v_max3_i32 v44, v44, v182, v183
    v_add_f32 v40, v40, v180
    v_add_f32 v41, v41, v181
    v_add_f32 v42, v42, v182
    v_add_f32 v43, v43, v183
    v_max3_i32 v44, v44, v184, v185
    v_max3_i32 v44, v44, v186, v187
    v_add_f32 v40, v40, v184
    v_add_f32 v41, v41, v185
    v_add_f32 v42, v42, v186
    v_add_f32 v43, v43, v187
    v_max3_i32 v44, v44, v188, v189
    v_max3_i32 v44, v44, v190, v191
    v_add_f32 v40, v40, v188
    v_add_f32 v41, v41, v189
    v_add_f32 v42, v42, v190
    v_add_f32 v43, v43, v191
    s_waitcnt vmcnt(0)
    s_mov_b32 exec_lo, s62
    s_mov_b32 exec_hi, s63
    s_set_gpr_idx_on s55, 0x8
    v_mov_b32 v192, v24
    v_mov_b32 v193, v25
    v_mov_b32 v194, v26
    v_mov_b32 v195, v27
    s_set_gpr_idx_off
    s_mov_b64 exec, -1
    v_max3_i32 v44, v44, v192, v193
    v_max3_i32 v44, v44, v194, v195
    v_max3_i32 v44, v44, v196, v197
    v_max3_i32 v44, v44, v198, v199
    v_add_f32 v52, v192, v196
    v_add_f32 v53, v193, v197
    v_add_f32 v54, v194, v198
    v_add_f32 v55, v195, v199
    v_max3_i32 v44, v44, v200, v201
    v_max3_i32 v44, v44, v202, v203
    v_add_f32 v52, v52, v200
    v_add_f32 v53, v53, v201
    v_add_f32 v54, v54, v202
    v_add_f32 v55, v55, v203
    v_max3_i32 v44, v44, v204, v205
    v_max3_i32 v44, v44, v206, v207
    v_add_f32 v52, v52, v204
    v_add_f32 v53, v53, v205
    v_add_f32 v54, v54, v206
    v_add_f32 v55, v55, v207
    v_cmp_eq_u32 vcc, 0x7fa5c3e1, v44
    s_add_u32 s61, s61, 1
    s_cmp_ge_u32 s61, 0x40000
    s_cbranch_scc1 L_fdone
    s_nop 1
    s_cbranch_vccz L_fdone
    s_mov_b32 s53, s52
    buffer_load_dwordx4 v[128:131], v47, s[36:39], s53 offen sc1
    s_add_u32 s53, s53, 5120
    buffer_load_dwordx4 v[132:135], v47, s[36:39], s53 offen sc1
    s_add_u32 s53, s53, 5120
    buffer_load_dwordx4 v[136:139], v47, s[36:39], s53 offen sc1
    s_add_u32 s53, s53, 5120
    buffer_load_dwordx4 v[140:143], v47, s[36:39], s53 offen sc1
    s_add_u32 s53, s53, 5120
    buffer_load_dwordx4 v[144:147], v47, s[36:39], s53 offen sc1
    s_add_u32 s53, s53, 5120
    buffer_load_dwordx4 v[148:151], v47, s[36:39], s53 offen sc1
    s_add_u32 s53, s53, 5120
    buffer_load_dwordx4 v[152:155], v47, s[36:39], s53 offen sc1
    s_add_u32 s53, s53, 5120
    buffer_load_dwordx4 v[156:159], v47, s[36:39], s53 offen sc1
    s_add_u32 s53, s53, 5120
    buffer_load_dwordx4 v[160:163], v47, s[36:39], s53 offen sc1
    s_add_u32 s53, s53, 5120
    buffer_load_dwordx4 v[164:167], v47, s[36:39], s53 offen sc1
    s_add_u32 s53, s53, 5120
    buffer_load_dwordx4 v[168:171], v47, s[36:39], s53 offen sc1
    s_add_u32 s53, s53, 5120
    buffer_load_dwordx4 v[172:175], v47, s[36:39], s53 offen sc1
    s_add_u32 s53, s53, 5120
    buffer_load_dwordx4 v[176:179], v47, s[36:39], s53 offen sc1
    s_add_u32 s53, s53, 5120
    buffer_load_dwordx4 v[180:183], v47, s[36:39], s53 offen sc1
    s_add_u32 s53, s53, 5120
    buffer_load_dwordx4 v[184:187], v47, s[36:39], s53 offen sc1
    s_add_u32 s53, s53, 5120
    buffer_load_dwordx4 v[188:191], v47, s[36:39], s53 offen sc1
    s_mov_b32 s53, 0
    buffer_load_dwordx4 v[192:195], v49, s[36:39], s53 offen sc1
    s_mov_b32 s53, 20480
    buffer_load_dwordx4 v[196:199], v49, s[36:39], s53 offen sc1
    s_mov_b32 s53, 40960
    buffer_load_dwordx4 v[200:203], v49, s[36:39], s53 offen sc1
    s_mov_b32 s53, 61440
    buffer_load_dwordx4 v[204:207], v49, s[36:39], s53 offen sc1
    s_branch L_ftry
L_fdone:
    v_mov_b32 v36, v40
    v_mov_b32 v37, v41
    v_mov_b32 v38, v42
    v_mov_b32 v39, v43
    v_add_f32_dpp v52, v52, v52 row_ror:8 row_mask:0xf bank_mask:0xf
    v_add_f32_dpp v53, v53, v53 row_ror:8 row_mask:0xf bank_mask:0xf
    v_add_f32_dpp v54, v54, v54 row_ror:8 row_mask:0xf bank_mask:0xf
    v_add_f32_dpp v55, v55, v55 row_ror:8 row_mask:0xf bank_mask:0xf
    v_permlane32_swap_b32 v36, v40
    v_permlane32_swap_b32 v37, v41
    v_permlane32_swap_b32 v38, v42
    v_permlane32_swap_b32 v39, v43
    v_mov_b32 v56, v52
    v_mov_b32 v57, v53
    v_mov_b32 v58, v54
    v_mov_b32 v59, v55
    v_add_f32 v40, v40, v36
    v_add_f32 v41, v41, v37
    v_add_f32 v42, v42, v38
    v_add_f32 v43, v43, v39
    v_permlane16_swap_b32 v56, v52
    v_permlane16_swap_b32 v57, v53
    v_permlane16_swap_b32 v58, v54
    v_permlane16_swap_b32 v59, v55
    v_cvt_pk_bf16_f32 v40, v40, v41
    v_cvt_pk_bf16_f32 v41, v42, v43
    s_mul_i32 s53, s30, 1280
    s_lshl_b32 s54, s32, 8
    s_add_u32 s54, s53, s54
    v_add_f32 v52, v52, v56
    v_add_f32 v53, v53, v57
    v_add_f32 v54, v54, v58
    v_add_f32 v55, v55, v59
    s_mov_b32 exec_hi, 0
    buffer_store_dwordx2 v[40:41], v4, s[44:47], s54 offen
    s_mov_b64 exec, -1
    v_mov_b32 v56, v52
    v_mov_b32 v57, v53
    v_mov_b32 v58, v54
    v_mov_b32 v59, v55
    s_nop 1
    v_permlane32_swap_b32 v56, v52
    v_permlane32_swap_b32 v57, v53
    v_permlane32_swap_b32 v58, v54
    v_permlane32_swap_b32 v59, v55
    s_lshl_b32 s54, s32, 6
    s_add_u32 s53, s53, s54
    s_add_u32 s53, s53, 1024
    v_add_f32 v52, v52, v56
    v_add_f32 v53, v53, v57
    v_add_f32 v54, v54, v58
    v_add_f32 v55, v55, v59
    v_cvt_pk_bf16_f32 v52, v52, v53
    v_cvt_pk_bf16_f32 v53, v54, v55
    s_mov_b64 exec, 0xff
    buffer_store_dwordx2 v[52:53], v4, s[44:47], s53 offen
    s_branch L_exit
L_notlast:
    s_waitcnt lgkmcnt(0)
    v_add_f32 v8, v8, v12
    v_add_f32 v16, v16, v20
    v_add_f32 v9, v9, v13
    v_add_f32 v17, v17, v21
    v_add_f32 v10, v10, v14
    v_add_f32 v18, v18, v22
    v_add_f32 v11, v11, v15
    v_add_f32 v19, v19, v23
    v_add_f32 v8, v8, v16
    v_add_f32 v9, v9, v17
    v_add_f32 v10, v10, v18
    v_add_f32 v11, v11, v19
    v_add_f32 v24, v24, v28
    v_add_f32 v32, v32, v36
    v_add_f32 v25, v25, v29
    v_add_f32 v33, v33, v37
    v_add_f32 v26, v26, v30
    v_add_f32 v34, v34, v38
    v_add_f32 v27, v27, v31
    v_add_f32 v35, v35, v39
    v_add_f32 v24, v24, v32
    v_add_f32 v25, v25, v33
    v_add_f32 v26, v26, v34
    v_add_f32 v27, v27, v35
    s_mov_b32 exec_hi, 0
    buffer_store_dwordx4 v[8:11], v4, s[36:39], s53 offen sc1
    s_mov_b64 exec, 0xff
    buffer_store_dwordx4 v[24:27], v4, s[36:39], s54 offen sc1
L_exit:
L_end:
    s_endpgm
    .fill 3072, 4, 0xbf810000
.section .rodata,"a"
.p2align 6
.amdhsa_kernel gated_mix__gqa_block_cached__glu_gated_reglu__decode_kernel
  .amdhsa_next_free_vgpr 256
  .amdhsa_next_free_sgpr 102
  .amdhsa_accum_offset 256
  .amdhsa_group_segment_fixed_size 0
  .amdhsa_kernarg_size 104
  .amdhsa_user_sgpr_count 2
  .amdhsa_user_sgpr_kernarg_segment_ptr 1
  .amdhsa_system_sgpr_workgroup_id_x 1
.end_amdhsa_kernel
```
